```python
import torch

def _softmax(x, axis=-1):
    return torch.softmax(x, dim=axis)
def _gelu(x):
    return torch.nn.functional.gelu(x, approximate="tanh")
def _silu(x):
    return torch.nn.functional.silu(x)
def _sigmoid(x):
    return torch.sigmoid(x)
def _layernorm(x, axis=-1, eps=1e-5):
    m = x.mean(dim=axis, keepdim=True)
    v = x.var(dim=axis, keepdim=True, unbiased=False)
    return (x - m) / torch.sqrt(v + eps)
def _scatter_add(tgt, idx, src, axis=0):
    return tgt.clone().index_add_(axis, idx, src)
def _segment_sum(src, seg, n):
    out = torch.zeros((n,) + src.shape[1:], dtype=src.dtype)
    return out.index_add_(0, seg, src)
def _pad(x, pw):
    flat = tuple(v for pair in reversed(pw) for v in pair)
    return torch.nn.functional.pad(x, flat)

kernel_name = 'concat_heads__mha_block_cached__mha_block_cached__near_ridge'

def setup_inputs():

    _w = (lambda a: (lambda t: t.to(torch.bfloat16) if t.is_floating_point() else t)(torch.as_tensor(a)))
    def _A_setup():
        B, Sq, D = 32, 32, 512
        H, Sk, Dh = 32, 32, 128
        return {
            "x": _w((lambda *s: torch.randn(*s, dtype=torch.bfloat16) * 0.8)(B, Sq, D)),
            "k_cache": _w((lambda *s: torch.randn(*s, dtype=torch.bfloat16) * 0.8)(B, H, Sk, Dh)),
            "v_cache": _w((lambda *s: torch.randn(*s, dtype=torch.bfloat16) * 0.05)(B, H, Sk, Dh)),
            "wq": _w((lambda *s: torch.randn(*s, dtype=torch.bfloat16) * 0.8)(D, H * Dh) * (D ** -0.5)),
            "wo": _w((lambda *s: torch.randn(*s, dtype=torch.bfloat16) * 0.05)(H * Dh, D) * ((H * Dh) ** -0.5)),
        }
    _A_in = _A_setup()

    def _B_setup():
        B, Sq, D = 32, 32, 512
        H, Sk, Dh = 32, 32, 128
        return {
            "x": _w((lambda *s: torch.randn(*s, dtype=torch.bfloat16) * 0.8)(B, Sq, D)),
            "k_cache": _w((lambda *s: torch.randn(*s, dtype=torch.bfloat16) * 0.8)(B, H, Sk, Dh)),
            "v_cache": _w((lambda *s: torch.randn(*s, dtype=torch.bfloat16) * 0.05)(B, H, Sk, Dh)),
            "wq": _w((lambda *s: torch.randn(*s, dtype=torch.bfloat16) * 0.8)(D, H * Dh) * (D ** -0.5)),
            "wo": _w((lambda *s: torch.randn(*s, dtype=torch.bfloat16) * 0.05)(H * Dh, D) * ((H * Dh) ** -0.5)),
        }
    _B_in = _B_setup()

    return {
        "A_x": _A_in["x"],
        "A_k_cache": _A_in["k_cache"],
        "A_v_cache": _A_in["v_cache"],
        "A_wq": _A_in["wq"],
        "A_wo": _A_in["wo"],
        "B_x": _B_in["x"],
        "B_k_cache": _B_in["k_cache"],
        "B_v_cache": _B_in["v_cache"],
        "B_wq": _B_in["wq"],
        "B_wo": _B_in["wo"],
    }

def reference(A_x, A_k_cache, A_v_cache, A_wq, A_wo, B_x, B_k_cache, B_v_cache, B_wq, B_wo):
    def _A_ref(x, k_cache, v_cache, wq, wo):
        B, Sq, D = x.shape
        H, Dh = 32, 128
        q = (lambda x, *d: x.permute(*d))((x @ wq).reshape(B, Sq, H, Dh), 0, 2, 1, 3)
        scores = torch.einsum("bhqd,bhkd->bhqk", q, k_cache) * (Dh ** -0.5)
        p = _softmax(scores, axis=-1)
        o = torch.einsum("bhqk,bhkd->bhqd", p, v_cache)
        return (lambda x, *d: x.permute(*d))(o, 0, 2, 1, 3).reshape(B, Sq, H * Dh) @ wo

    def _B_ref(x, k_cache, v_cache, wq, wo):
        B, Sq, D = x.shape
        H, Dh = 32, 128
        q = (lambda x, *d: x.permute(*d))((x @ wq).reshape(B, Sq, H, Dh), 0, 2, 1, 3)
        scores = torch.einsum("bhqd,bhkd->bhqk", q, k_cache) * (Dh ** -0.5)
        p = _softmax(scores, axis=-1)
        o = torch.einsum("bhqk,bhkd->bhqd", p, v_cache)
        return (lambda x, *d: x.permute(*d))(o, 0, 2, 1, 3).reshape(B, Sq, H * Dh) @ wo

    a = _A_ref(A_x, A_k_cache, A_v_cache, A_wq, A_wo)
    b = _B_ref(B_x, B_k_cache, B_v_cache, B_wq, B_wo)
    return torch.concatenate([a, b], axis=-1)
```

```asm
; @launch grid=(256,1,1) block=(256,1,1) lds=163840
.amdgcn_target "amdgcn-amd-amdhsa--gfx950"
.text
.globl concat_heads__mha_block_cached__mha_block_cached__near_ridge_kernel
.p2align 8
.type concat_heads__mha_block_cached__mha_block_cached__near_ridge_kernel,@function
concat_heads__mha_block_cached__mha_block_cached__near_ridge_kernel:
    s_cmp_ge_u32 s2, 256
    s_cbranch_scc1 L_main_end
    s_bfe_u32 s20, s2, 0x10002
    s_mul_i32 s3, s20, 40
    s_add_u32 s10, s0, s3
    s_addc_u32 s11, s1, 0
    s_load_dwordx2 s[40:41], s[10:11], 0
    s_load_dwordx2 s[52:53], s[10:11], 24
    s_getpc_b64 s[64:65]
L_pc:
    s_lshr_b32 s3, s2, 3
    v_lshl_add_u32 v40, s3, 8, v0
    v_lshlrev_b32 v40, 3, v40
    v_min_u32 v40, L_main_end-L_pc-4, v40
    v_add_co_u32 v40, vcc, s64, v40
    v_mov_b32 v41, s65
    v_readfirstlane_b32 s24, v0
    v_addc_co_u32 v41, vcc, 0, v41, vcc
    global_load_dword v56, v[40:41], off
    v_and_b32 v0, 63, v0
    s_lshr_b32 s22, s2, 5
    s_lshr_b32 s3, s2, 4
    s_xor_b32 s3, s3, s22
    s_and_b32 s25, s3, 1
    s_lshr_b32 s24, s24, 6
    s_lshr_b32 s3, s2, 2
    s_and_b32 s100, s3, 6
    s_xor_b32 s26, s100, s22
    s_bfe_u32 s19, s2, 0x10004
    s_and_b32 s3, s22, 6
    s_mul_i32 s3, s3, 3
    s_add_u32 s31, s22, s3
    s_xor_b32 s3, s24, s19
    s_lshl1_add_u32 s29, s3, s31
    s_lshl_b32 s29, s29, 8
    s_lshr_b32 s3, s26, 1
    s_add_u32 s29, s29, s3
    s_lshl_b32 s29, s29, 7
    s_lshl_b32 s37, s24, 12
    s_mov_b32 s42, 1048576
    s_mov_b32 s43, 0x20000
    v_lshrrev_b32 v2, 4, v0
    s_lshl_b32 s3, s26, 2
    v_xor_b32 v40, v0, v2
    v_xor_b32 v40, s3, v40
    v_and_b32 v40, 7, v40
    v_lshlrev_b32 v40, 4, v40
    v_lshrrev_b32 v41, 3, v0
    v_lshl_add_u32 v44, v41, 10, v40
    v_xor_b32 v40, 64, v44
    v_add_u32 v45, 7168, v40
    v_add_u32 v46, 14336, v44
    v_add_u32 v47, 21504, v40
    s_add_u32 m0, s37, 98304
    s_xor_b32 s33, s29, 0
    s_waitcnt lgkmcnt(0)
    s_bitcmp1_b32 s2, 7
    s_cbranch_scc0 L_nox0
    buffer_load_dwordx4 v44, s[40:43], s33 offen offset:0  lds
    buffer_load_dwordx4 v45, s[40:43], s33 offen offset:1024  lds
    buffer_load_dwordx4 v46, s[40:43], s33 offen offset:2048  lds
    buffer_load_dwordx4 v47, s[40:43], s33 offen offset:3072  lds
L_nox0:
    s_and_b32 s21, s2, 3
    s_lshl3_add_u32 s100, s21, s100
    s_add_u32 s100, s100, s25
    s_and_b32 s3, s24, 1
    s_xor_b32 s39, s100, s3
    s_lshr_b32 s23, s24, 1
    s_lshl1_add_u32 s36, s3, s23
    s_lshl_b32 s36, s36, 12
    s_lshl3_add_u32 s30, s26, s23
    s_lshl_b32 s30, s30, 7
    s_add_u32 s30, s30, s39
    s_lshl_b32 s30, s30, 8
    s_mov_b32 s54, 4194304
    s_mov_b32 s55, 0x20000
    v_and_b32 v1, 15, v0
    v_lshlrev_b32 v3, 1, v2
    v_xor_b32 v3, v3, v1
    v_lshlrev_b32 v3, 4, v3
    v_lshl_add_u32 v4, v2, 13, v3
    v_xor_b32 v40, 128, v4
    v_add_u32 v5, 64512, v40
    v_add_u32 v6, 129024, v4
    v_add_u32 v7, 193536, v40
    s_bitcmp1_b32 s2, 7
    s_cbranch_scc0 L_now0
    s_add_u32 m0, s36, 0
    s_xor_b32 s33, s30, 0
    buffer_load_dwordx4 v4, s[52:55], s33 offen offset:0  lds
    buffer_load_dwordx4 v5, s[52:55], s33 offen offset:1024  lds
    buffer_load_dwordx4 v6, s[52:55], s33 offen offset:2048  lds
    buffer_load_dwordx4 v7, s[52:55], s33 offen offset:3072  lds
L_now0:
    s_load_dwordx2 s[44:45], s[10:11], 8
    s_load_dwordx2 s[48:49], s[10:11], 16
    s_load_dwordx2 s[56:57], s[10:11], 32
    s_load_dwordx2 s[60:61], s[0:1], 96
    s_load_dwordx4 s[4:7], s[0:1], 80
    s_bfe_u32 s23, s2, 0x20003
    s_lshr_b32 s3, s23, 1
    s_lshl1_add_u32 s27, s21, s3
    s_and_b32 s3, s22, 7
    s_xor_b32 s3, s27, s3
    s_lshr_b32 s28, s3, 1
    s_lshl_b32 s38, s24, 13
    s_mov_b32 s46, 8388608
    s_mov_b32 s47, 0x20000
    s_mov_b32 s50, 8388608
    s_mov_b32 s51, 0x20000
    s_mov_b32 s58, 4194304
    s_mov_b32 s59, 0x20000
    s_mov_b32 s62, 33685504
    s_mov_b32 s63, 0x20000
    s_lshl1_add_u32 s26, s24, s31
    s_and_b32 s3, s24, 2
    s_add_u32 s3, s3, s19
    s_lshl1_add_u32 s31, s3, s31
    s_lshl_b32 s31, s31, 18
    s_lshl_b32 s3, s39, 13
    s_add_u32 s31, s31, s3
    s_lshl_b32 s26, s26, 18
    s_lshl_b32 s3, s100, 13
    s_add_u32 s26, s26, s3
    s_lshl_b32 s32, s100, 17
    s_lshl_b32 s3, s24, 15
    s_add_u32 s32, s32, s3
    s_and_b32 s39, s23, 1
    s_lshl_b32 s3, s39, 9
    s_add_u32 s32, s32, s3
    s_lshl_b32 s3, s28, 7
    s_add_u32 s32, s32, s3
    s_lshr_b32 s18, s26, 18
    s_lshl_b32 s18, s18, 16
    s_and_b32 s3, s32, 1023
    s_add_u32 s18, s18, s3
    s_lshl_b32 s3, s20, 10
    s_add_u32 s18, s18, s3
    s_lshl_b32 s3, s25, 6
    s_add_u32 s18, s18, s3
    s_lshl_b32 s13, s20, 3
    s_add_u32 s13, s13, s22
    s_lshl_b32 s3, s13, 1
    s_add_u32 s3, s3, s39
    s_lshl_b32 s3, s3, 3
    s_add_u32 s3, s3, s27
    s_lshl_b32 s13, s13, 4
    s_lshl_b32 s17, s3, 16
    s_lshl_b32 s3, s3, 2
    s_add_u32 s3, s3, s24
    s_lshl_b32 s12, s3, 7
    s_lshl_b32 s16, s3, 12
    s_lshl_b32 s3, s24, 11
    s_add_u32 s17, s17, s3
    s_add_u32 s17, s17, 16777216
    s_waitcnt lgkmcnt(0)
    s_add_u32 s8, s60, 0x2000000
    s_addc_u32 s9, s61, 0
    s_and_b32 s3, s22, 3
    s_xor_b32 s3, s3, s21
    s_or_b32 s15, s3, s23
    s_lshl_b32 s3, s13, 9
    s_lshr_b32 s33, s37, 1
    s_add_u32 s3, s3, s33
    s_add_u32 s3, s3, 0x2000000
    s_cmp_eq_u32 s15, 0
    s_cselect_b32 s3, s3, 0x4000000
    s_or_b32 s15, s15, s24
    v_lshlrev_b32 v14, 4, v0
    v_mov_b32 v60, 0
    v_mov_b32 v61, 0
    v_mov_b32 v62, 0
    v_mov_b32 v63, 0
    buffer_store_dwordx4 v[60:63], v14, s[60:63], s3 offen offset:0 sc1
    buffer_store_dwordx4 v[60:63], v14, s[60:63], s3 offen offset:1024 sc1
    v_lshl_add_u32 v12, v2, 8, v3
    v_xor_b32 v13, 128, v12
    v_xor_b32 v24, v1, v2
    v_lshlrev_b32 v24, 4, v24
    v_lshl_add_u32 v24, v2, 8, v24
    v_xor_b32 v25, 64, v24
    v_xor_b32 v26, 128, v24
    v_xor_b32 v27, 192, v24
    v_lshrrev_b32 v40, 2, v0
    v_and_b32 v41, 7, v40
    v_lshlrev_b32 v41, 5, v41
    v_lshl_add_u32 v40, v40, 8, v41
    v_and_b32 v41, 3, v0
    v_lshl_add_u32 v40, v41, 3, v40
    s_and_b32 s3, s36, 0x2000
    v_add_u32 v40, s3, v40
    v_xor_b32 v48, 0, v40
    v_xor_b32 v49, 32, v40
    v_xor_b32 v50, 64, v40
    v_xor_b32 v51, 96, v40
    v_xor_b32 v52, 128, v40
    v_xor_b32 v53, 160, v40
    v_xor_b32 v54, 192, v40
    v_xor_b32 v55, 224, v40
    s_and_b32 s3, s38, 0x4000
    s_add_u32 s3, s3, 65536
    v_add_u32 v16, s3, v48
    v_add_u32 v17, s3, v49
    v_add_u32 v18, s3, v50
    v_add_u32 v19, s3, v51
    v_add_u32 v20, s3, v52
    v_add_u32 v21, s3, v53
    v_add_u32 v22, s3, v54
    v_add_u32 v23, s3, v55
    v_lshrrev_b32 v40, 1, v1
    v_xor_b32 v40, v40, v2
    v_lshlrev_b32 v40, 4, v40
    v_lshl_add_u32 v40, v1, 7, v40
    s_and_b32 s3, s37, 0x2000
    s_add_u32 s3, s3, 98304
    v_add_u32 v28, s3, v40
    v_xor_b32 v29, 64, v28
    v_lshrrev_b32 v40, 1, v2
    v_xor_b32 v40, v40, v1
    v_lshlrev_b32 v40, 4, v40
    v_lshl_add_u32 v40, v1, 8, v40
    v_and_b32 v41, 1, v2
    v_lshl_add_u32 v40, v41, 3, v40
    s_add_u32 s3, s38, 65536
    v_add_u32 v40, s3, v40
    v_xor_b32 v32, 0, v40
    v_xor_b32 v33, 32, v40
    v_xor_b32 v34, 64, v40
    v_xor_b32 v35, 96, v40
    v_xor_b32 v36, 128, v40
    v_xor_b32 v37, 160, v40
    v_xor_b32 v38, 192, v40
    v_xor_b32 v39, 224, v40
    s_add_u32 s3, s37, 131072
    v_add_u32 v30, s3, v14
    s_and_b32 s3, s37, 0x1000
    s_lshr_b32 s3, s3, 1
    s_sub_u32 s27, s16, s3
    v_subrev_u32 v31, s3, v30
    s_lshl_b32 s3, s19, 11
    s_xor_b32 s27, s27, s3
    v_xor_b32 v31, s3, v31
    v_lshlrev_b32 v15, 11, v1
    v_lshl_add_u32 v15, v41, 5, v15
    v_lshrrev_b32 v41, 1, v2
    v_lshl_add_u32 v15, v41, 4, v15
    s_mov_b32 s34, 0x3e0293ee
    s_mov_b32 s35, 0xbe0293ee
    v_and_b32 v40, 7, v0
    v_lshlrev_b32 v41, 1, v2
    v_xor_b32 v40, v40, v41
    s_lshl_b32 s3, s25, 2
    v_xor_b32 v40, s3, v40
    v_lshlrev_b32 v40, 4, v40
    v_lshrrev_b32 v41, 3, v0
    v_lshl_add_u32 v8, v41, 10, v40
    v_add_u32 v9, 7168, v8
    v_add_u32 v10, 14336, v8
    v_add_u32 v11, 21504, v8
    v_and_b32 v41, 3, v41
    v_lshlrev_b32 v41, 5, v41
    v_lshrrev_b32 v40, 2, v0
    v_lshl_add_u32 v41, v40, 7, v41
    v_and_b32 v40, 3, v0
    v_lshl_add_u32 v0, v40, 3, v41
    v_xor_b32 v1, 32, v0
    v_xor_b32 v2, 64, v0
    v_xor_b32 v3, 96, v0
    s_mov_b32 s20, 1
    s_mov_b32 s21, 16
    s_mov_b32 s22, 256
    s_mov_b32 s23, 4096
    s_mov_b32 s25, 65536
    s_mov_b32 s28, 1048576
    s_bfe_u32 s3, s2, 0x10007
    s_cmp_eq_u32 s3, 1
    s_cbranch_scc1 L_var1
L_var0:
    s_add_u32 m0, s37, 98304
    s_xor_b32 s33, s29, 256
    buffer_load_dwordx4 v44, s[40:43], s33 offen offset:0  lds
    buffer_load_dwordx4 v45, s[40:43], s33 offen offset:1024  lds
    buffer_load_dwordx4 v46, s[40:43], s33 offen offset:2048  lds
    buffer_load_dwordx4 v47, s[40:43], s33 offen offset:3072  lds
    s_add_u32 m0, s36, 0
    s_xor_b32 s33, s30, 1048576
    buffer_load_dwordx4 v4, s[52:55], s33 offen offset:0  lds
    buffer_load_dwordx4 v5, s[52:55], s33 offen offset:1024  lds
    buffer_load_dwordx4 v6, s[52:55], s33 offen offset:2048  lds
    buffer_load_dwordx4 v7, s[52:55], s33 offen offset:3072  lds
    s_add_u32 m0, s38, 65536
    s_xor_b32 s33, s31, 0
    buffer_load_dwordx4 v24, s[44:47], s33 offen offset:0 nt lds
    buffer_load_dwordx4 v25, s[44:47], s33 offen offset:1024 nt lds
    buffer_load_dwordx4 v26, s[44:47], s33 offen offset:2048 nt lds
    buffer_load_dwordx4 v27, s[44:47], s33 offen offset:3072 nt lds
    s_add_u32 m0, s38, 69632
    s_xor_b32 s33, s31, 4096
    buffer_load_dwordx4 v24, s[44:47], s33 offen offset:0 nt lds
    buffer_load_dwordx4 v25, s[44:47], s33 offen offset:1024 nt lds
    buffer_load_dwordx4 v26, s[44:47], s33 offen offset:2048 nt lds
    buffer_load_dwordx4 v27, s[44:47], s33 offen offset:3072 nt lds
    s_waitcnt vmcnt(8)
    s_barrier
    ds_read_b128 a[64:67], v28 offset:0
    ds_read_b128 a[68:71], v28 offset:2048
    ds_read_b128 a[72:75], v28 offset:4096
    ds_read_b128 a[76:79], v28 offset:6144
    ds_read_b64_tr_b16 a[0:1], v48 offset:0
    ds_read_b64_tr_b16 a[2:3], v48 offset:4096
    ds_read_b64_tr_b16 a[4:5], v49 offset:0
    ds_read_b64_tr_b16 a[6:7], v49 offset:4096
    ds_read_b64_tr_b16 a[8:9], v50 offset:0
    ds_read_b64_tr_b16 a[10:11], v50 offset:4096
    ds_read_b64_tr_b16 a[12:13], v51 offset:0
    ds_read_b64_tr_b16 a[14:15], v51 offset:4096
    ds_read_b64_tr_b16 a[16:17], v52 offset:0
    ds_read_b64_tr_b16 a[18:19], v52 offset:4096
    ds_read_b64_tr_b16 a[20:21], v53 offset:0
    ds_read_b64_tr_b16 a[22:23], v53 offset:4096
    ds_read_b64_tr_b16 a[24:25], v54 offset:0
    ds_read_b64_tr_b16 a[26:27], v54 offset:4096
    ds_read_b64_tr_b16 a[28:29], v55 offset:0
    ds_read_b64_tr_b16 a[30:31], v55 offset:4096
    s_add_u32 m0, s36, 16384
    s_xor_b32 s33, s30, 1310720
    buffer_load_dwordx4 v4, s[52:55], s33 offen offset:0  lds
    buffer_load_dwordx4 v5, s[52:55], s33 offen offset:1024  lds
    buffer_load_dwordx4 v6, s[52:55], s33 offen offset:2048  lds
    buffer_load_dwordx4 v7, s[52:55], s33 offen offset:3072  lds
    s_waitcnt vmcnt(0) lgkmcnt(0)
    s_barrier
    v_mfma_f32_16x16x32_bf16 v[128:131], a[0:3], a[64:67], 0
    ds_read_b128 a[80:83], v29 offset:0
    s_add_u32 m0, s37, 114688
    v_mfma_f32_16x16x32_bf16 v[136:139], a[0:3], a[68:71], 0
    ds_read_b128 a[84:87], v29 offset:2048
    s_xor_b32 s33, s29, 384
    v_mfma_f32_16x16x32_bf16 v[144:147], a[0:3], a[72:75], 0
    buffer_load_dwordx4 v44, s[40:43], s33 offen offset:0  lds
    v_mfma_f32_16x16x32_bf16 v[152:155], a[0:3], a[76:79], 0
    ds_read_b128 a[88:91], v29 offset:4096
    v_mfma_f32_16x16x32_bf16 v[156:159], a[4:7], a[76:79], 0
    ds_read_b128 a[92:95], v29 offset:6144
    v_mfma_f32_16x16x32_bf16 v[148:151], a[4:7], a[72:75], 0
    ds_read_b64_tr_b16 a[32:33], v48 offset:16384
    v_mfma_f32_16x16x32_bf16 v[140:143], a[4:7], a[68:71], 0
    buffer_load_dwordx4 v45, s[40:43], s33 offen offset:1024  lds
    v_mfma_f32_16x16x32_bf16 v[132:135], a[4:7], a[64:67], 0
    ds_read_b64_tr_b16 a[34:35], v48 offset:20480
    v_mfma_f32_16x16x32_bf16 v[160:163], a[8:11], a[64:67], 0
    ds_read_b64_tr_b16 a[36:37], v49 offset:16384
    v_mfma_f32_16x16x32_bf16 v[168:171], a[8:11], a[68:71], 0
    ds_read_b64_tr_b16 a[38:39], v49 offset:20480
    v_mfma_f32_16x16x32_bf16 v[176:179], a[8:11], a[72:75], 0
    buffer_load_dwordx4 v46, s[40:43], s33 offen offset:2048  lds
    v_mfma_f32_16x16x32_bf16 v[184:187], a[8:11], a[76:79], 0
    ds_read_b64_tr_b16 a[40:41], v50 offset:16384
    v_mfma_f32_16x16x32_bf16 v[188:191], a[12:15], a[76:79], 0
    ds_read_b64_tr_b16 a[42:43], v50 offset:20480
    v_mfma_f32_16x16x32_bf16 v[180:183], a[12:15], a[72:75], 0
    ds_read_b64_tr_b16 a[44:45], v51 offset:16384
    v_mfma_f32_16x16x32_bf16 v[172:175], a[12:15], a[68:71], 0
    buffer_load_dwordx4 v47, s[40:43], s33 offen offset:3072  lds
    s_add_u32 m0, s36, 32768
    v_mfma_f32_16x16x32_bf16 v[164:167], a[12:15], a[64:67], 0
    ds_read_b64_tr_b16 a[46:47], v51 offset:20480
    s_xor_b32 s33, s30, 1572864
    v_mfma_f32_16x16x32_bf16 v[192:195], a[16:19], a[64:67], 0
    ds_read_b64_tr_b16 a[48:49], v52 offset:16384
    v_mfma_f32_16x16x32_bf16 v[200:203], a[16:19], a[68:71], 0
    ds_read_b64_tr_b16 a[50:51], v52 offset:20480
    v_mfma_f32_16x16x32_bf16 v[208:211], a[16:19], a[72:75], 0
    buffer_load_dwordx4 v4, s[52:55], s33 offen offset:0  lds
    v_mfma_f32_16x16x32_bf16 v[216:219], a[16:19], a[76:79], 0
    ds_read_b64_tr_b16 a[52:53], v53 offset:16384
    v_mfma_f32_16x16x32_bf16 v[220:223], a[20:23], a[76:79], 0
    ds_read_b64_tr_b16 a[54:55], v53 offset:20480
    v_mfma_f32_16x16x32_bf16 v[212:215], a[20:23], a[72:75], 0
    ds_read_b64_tr_b16 a[56:57], v54 offset:16384
    v_mfma_f32_16x16x32_bf16 v[204:207], a[20:23], a[68:71], 0
    buffer_load_dwordx4 v5, s[52:55], s33 offen offset:1024  lds
    v_mfma_f32_16x16x32_bf16 v[196:199], a[20:23], a[64:67], 0
    ds_read_b64_tr_b16 a[58:59], v54 offset:20480
    v_mfma_f32_16x16x32_bf16 v[224:227], a[24:27], a[64:67], 0
    ds_read_b64_tr_b16 a[60:61], v55 offset:16384
    v_mfma_f32_16x16x32_bf16 v[232:235], a[24:27], a[68:71], 0
    ds_read_b64_tr_b16 a[62:63], v55 offset:20480
    v_mfma_f32_16x16x32_bf16 v[240:243], a[24:27], a[72:75], 0
    buffer_load_dwordx4 v6, s[52:55], s33 offen offset:2048  lds
    v_mfma_f32_16x16x32_bf16 v[248:251], a[24:27], a[76:79], 0
    v_mfma_f32_16x16x32_bf16 v[252:255], a[28:31], a[76:79], 0
    v_mfma_f32_16x16x32_bf16 v[244:247], a[28:31], a[72:75], 0
    v_mfma_f32_16x16x32_bf16 v[236:239], a[28:31], a[68:71], 0
    buffer_load_dwordx4 v7, s[52:55], s33 offen offset:3072  lds
    v_mfma_f32_16x16x32_bf16 v[228:231], a[28:31], a[64:67], 0
    s_waitcnt vmcnt(0) lgkmcnt(0)
    s_barrier
    s_cmp_lg_u32 s15, 0
    s_cbranch_scc1 L_nohs0
    s_atomic_add s20, s[6:7], s13
L_nohs0:
    v_mfma_f32_16x16x32_bf16 v[128:131], a[32:35], a[80:83], v[128:131]
    ds_read_b128 a[64:67], v28 offset:16384
    s_add_u32 m0, s36, 49152
    v_mfma_f32_16x16x32_bf16 v[136:139], a[32:35], a[84:87], v[136:139]
    ds_read_b128 a[68:71], v28 offset:18432
    s_xor_b32 s33, s30, 1835008
    v_mfma_f32_16x16x32_bf16 v[144:147], a[32:35], a[88:91], v[144:147]
    buffer_load_dwordx4 v4, s[52:55], s33 offen offset:0  lds
    v_mfma_f32_16x16x32_bf16 v[152:155], a[32:35], a[92:95], v[152:155]
    ds_read_b128 a[72:75], v28 offset:20480
    ds_read_b128 a[76:79], v28 offset:22528
    v_mfma_f32_16x16x32_bf16 v[156:159], a[36:39], a[92:95], v[156:159]
    ds_read_b64_tr_b16 a[0:1], v48 offset:32768
    ds_read_b64_tr_b16 a[2:3], v48 offset:36864
    v_mfma_f32_16x16x32_bf16 v[148:151], a[36:39], a[88:91], v[148:151]
    ds_read_b64_tr_b16 a[4:5], v49 offset:32768
    ds_read_b64_tr_b16 a[6:7], v49 offset:36864
    v_mfma_f32_16x16x32_bf16 v[140:143], a[36:39], a[84:87], v[140:143]
    buffer_load_dwordx4 v5, s[52:55], s33 offen offset:1024  lds
    v_mfma_f32_16x16x32_bf16 v[132:135], a[36:39], a[80:83], v[132:135]
    ds_read_b64_tr_b16 a[8:9], v50 offset:32768
    ds_read_b64_tr_b16 a[10:11], v50 offset:36864
    v_mfma_f32_16x16x32_bf16 v[160:163], a[40:43], a[80:83], v[160:163]
    ds_read_b64_tr_b16 a[12:13], v51 offset:32768
    ds_read_b64_tr_b16 a[14:15], v51 offset:36864
    v_mfma_f32_16x16x32_bf16 v[168:171], a[40:43], a[84:87], v[168:171]
    ds_read_b64_tr_b16 a[16:17], v52 offset:32768
    ds_read_b64_tr_b16 a[18:19], v52 offset:36864
    v_mfma_f32_16x16x32_bf16 v[176:179], a[40:43], a[88:91], v[176:179]
    buffer_load_dwordx4 v6, s[52:55], s33 offen offset:2048  lds
    v_mfma_f32_16x16x32_bf16 v[184:187], a[40:43], a[92:95], v[184:187]
    ds_read_b64_tr_b16 a[20:21], v53 offset:32768
    ds_read_b64_tr_b16 a[22:23], v53 offset:36864
    v_mfma_f32_16x16x32_bf16 v[188:191], a[44:47], a[92:95], v[188:191]
    ds_read_b64_tr_b16 a[24:25], v54 offset:32768
    ds_read_b64_tr_b16 a[26:27], v54 offset:36864
    v_mfma_f32_16x16x32_bf16 v[180:183], a[44:47], a[88:91], v[180:183]
    ds_read_b64_tr_b16 a[28:29], v55 offset:32768
    ds_read_b64_tr_b16 a[30:31], v55 offset:36864
    v_mfma_f32_16x16x32_bf16 v[172:175], a[44:47], a[84:87], v[172:175]
    buffer_load_dwordx4 v7, s[52:55], s33 offen offset:3072  lds
    v_mfma_f32_16x16x32_bf16 v[164:167], a[44:47], a[80:83], v[164:167]
    ds_read_b64 a[128:129], v32 offset:0
    ds_read_b64 a[144:145], v32 offset:4096
    v_mfma_f32_16x16x32_bf16 v[192:195], a[48:51], a[80:83], v[192:195]
    ds_read_b64 a[130:131], v33 offset:0
    ds_read_b64 a[146:147], v33 offset:4096
    v_mfma_f32_16x16x32_bf16 v[200:203], a[48:51], a[84:87], v[200:203]
    ds_read_b64 a[132:133], v34 offset:0
    ds_read_b64 a[148:149], v34 offset:4096
    v_mfma_f32_16x16x32_bf16 v[208:211], a[48:51], a[88:91], v[208:211]
    ds_read_b64 a[134:135], v35 offset:0
    v_mfma_f32_16x16x32_bf16 v[216:219], a[48:51], a[92:95], v[216:219]
    ds_read_b64 a[150:151], v35 offset:4096
    v_mfma_f32_16x16x32_bf16 v[220:223], a[52:55], a[92:95], v[220:223]
    ds_read_b64 a[136:137], v36 offset:0
    v_mfma_f32_16x16x32_bf16 v[212:215], a[52:55], a[88:91], v[212:215]
    ds_read_b64 a[152:153], v36 offset:4096
    v_mfma_f32_16x16x32_bf16 v[204:207], a[52:55], a[84:87], v[204:207]
    ds_read_b64 a[138:139], v37 offset:0
    v_mfma_f32_16x16x32_bf16 v[196:199], a[52:55], a[80:83], v[196:199]
    ds_read_b64 a[154:155], v37 offset:4096
    v_mfma_f32_16x16x32_bf16 v[224:227], a[56:59], a[80:83], v[224:227]
    ds_read_b64 a[140:141], v38 offset:0
    v_mfma_f32_16x16x32_bf16 v[232:235], a[56:59], a[84:87], v[232:235]
    ds_read_b64 a[156:157], v38 offset:4096
    v_mfma_f32_16x16x32_bf16 v[240:243], a[56:59], a[88:91], v[240:243]
    ds_read_b64 a[142:143], v39 offset:0
    v_mfma_f32_16x16x32_bf16 v[248:251], a[56:59], a[92:95], v[248:251]
    ds_read_b64 a[158:159], v39 offset:4096
    v_mfma_f32_16x16x32_bf16 v[252:255], a[60:63], a[92:95], v[252:255]
    v_mfma_f32_16x16x32_bf16 v[244:247], a[60:63], a[88:91], v[244:247]
    v_mfma_f32_16x16x32_bf16 v[236:239], a[60:63], a[84:87], v[236:239]
    v_mfma_f32_16x16x32_bf16 v[228:231], a[60:63], a[80:83], v[228:231]
    ds_read_b32 v58, v14
    s_waitcnt vmcnt(0) lgkmcnt(1)
    s_barrier
    v_mfma_f32_16x16x32_bf16 v[128:131], a[0:3], a[64:67], v[128:131]
    ds_read_b128 a[80:83], v29 offset:16384
    s_add_u32 m0, s38, 65536
    v_mfma_f32_16x16x32_bf16 v[136:139], a[0:3], a[68:71], v[136:139]
    ds_read_b128 a[84:87], v29 offset:18432
    s_xor_b32 s33, s31, 524288
    v_mfma_f32_16x16x32_bf16 v[144:147], a[0:3], a[72:75], v[144:147]
    buffer_load_dwordx4 v24, s[44:47], s33 offen offset:0 nt lds
    v_mfma_f32_16x16x32_bf16 v[152:155], a[0:3], a[76:79], v[152:155]
    ds_read_b128 a[88:91], v29 offset:20480
    v_mfma_f32_16x16x32_bf16 v[156:159], a[4:7], a[76:79], v[156:159]
    ds_read_b128 a[92:95], v29 offset:22528
    v_mfma_f32_16x16x32_bf16 v[148:151], a[4:7], a[72:75], v[148:151]
    ds_read_b64_tr_b16 a[32:33], v48 offset:49152
    v_mfma_f32_16x16x32_bf16 v[140:143], a[4:7], a[68:71], v[140:143]
    buffer_load_dwordx4 v25, s[44:47], s33 offen offset:1024 nt lds
    v_mfma_f32_16x16x32_bf16 v[132:135], a[4:7], a[64:67], v[132:135]
    ds_read_b64_tr_b16 a[34:35], v48 offset:53248
    v_mfma_f32_16x16x32_bf16 v[160:163], a[8:11], a[64:67], v[160:163]
    ds_read_b64_tr_b16 a[36:37], v49 offset:49152
    v_mfma_f32_16x16x32_bf16 v[168:171], a[8:11], a[68:71], v[168:171]
    ds_read_b64_tr_b16 a[38:39], v49 offset:53248
    v_mfma_f32_16x16x32_bf16 v[176:179], a[8:11], a[72:75], v[176:179]
    buffer_load_dwordx4 v26, s[44:47], s33 offen offset:2048 nt lds
    v_mfma_f32_16x16x32_bf16 v[184:187], a[8:11], a[76:79], v[184:187]
    ds_read_b64_tr_b16 a[40:41], v50 offset:49152
    v_mfma_f32_16x16x32_bf16 v[188:191], a[12:15], a[76:79], v[188:191]
    ds_read_b64_tr_b16 a[42:43], v50 offset:53248
    v_mfma_f32_16x16x32_bf16 v[180:183], a[12:15], a[72:75], v[180:183]
    ds_read_b64_tr_b16 a[44:45], v51 offset:49152
    v_mfma_f32_16x16x32_bf16 v[172:175], a[12:15], a[68:71], v[172:175]
    buffer_load_dwordx4 v27, s[44:47], s33 offen offset:3072 nt lds
    s_add_u32 m0, s38, 69632
    v_mfma_f32_16x16x32_bf16 v[164:167], a[12:15], a[64:67], v[164:167]
    ds_read_b64_tr_b16 a[46:47], v51 offset:53248
    s_xor_b32 s33, s31, 528384
    v_mfma_f32_16x16x32_bf16 v[192:195], a[16:19], a[64:67], v[192:195]
    ds_read_b64_tr_b16 a[48:49], v52 offset:49152
    v_mfma_f32_16x16x32_bf16 v[200:203], a[16:19], a[68:71], v[200:203]
    ds_read_b64_tr_b16 a[50:51], v52 offset:53248
    v_mfma_f32_16x16x32_bf16 v[208:211], a[16:19], a[72:75], v[208:211]
    buffer_load_dwordx4 v24, s[44:47], s33 offen offset:0 nt lds
    v_mfma_f32_16x16x32_bf16 v[216:219], a[16:19], a[76:79], v[216:219]
    ds_read_b64_tr_b16 a[52:53], v53 offset:49152
    v_mfma_f32_16x16x32_bf16 v[220:223], a[20:23], a[76:79], v[220:223]
    ds_read_b64_tr_b16 a[54:55], v53 offset:53248
    v_mfma_f32_16x16x32_bf16 v[212:215], a[20:23], a[72:75], v[212:215]
    ds_read_b64_tr_b16 a[56:57], v54 offset:49152
    v_mfma_f32_16x16x32_bf16 v[204:207], a[20:23], a[68:71], v[204:207]
    buffer_load_dwordx4 v25, s[44:47], s33 offen offset:1024 nt lds
    v_mfma_f32_16x16x32_bf16 v[196:199], a[20:23], a[64:67], v[196:199]
    ds_read_b64_tr_b16 a[58:59], v54 offset:53248
    v_mfma_f32_16x16x32_bf16 v[224:227], a[24:27], a[64:67], v[224:227]
    ds_read_b64_tr_b16 a[60:61], v55 offset:49152
    v_mfma_f32_16x16x32_bf16 v[232:235], a[24:27], a[68:71], v[232:235]
    ds_read_b64_tr_b16 a[62:63], v55 offset:53248
    v_mfma_f32_16x16x32_bf16 v[240:243], a[24:27], a[72:75], v[240:243]
    buffer_load_dwordx4 v26, s[44:47], s33 offen offset:2048 nt lds
    v_mfma_f32_16x16x32_bf16 v[248:251], a[24:27], a[76:79], v[248:251]
    v_mfma_f32_16x16x32_bf16 v[252:255], a[28:31], a[76:79], v[252:255]
    v_mfma_f32_16x16x32_bf16 v[244:247], a[28:31], a[72:75], v[244:247]
    v_mfma_f32_16x16x32_bf16 v[236:239], a[28:31], a[68:71], v[236:239]
    buffer_load_dwordx4 v27, s[44:47], s33 offen offset:3072 nt lds
    v_mfma_f32_16x16x32_bf16 v[228:231], a[28:31], a[64:67], v[228:231]
    s_add_u32 m0, s37, 131072
    s_xor_b32 s33, s29, 0
    buffer_load_dwordx4 v44, s[40:43], s33 offen offset:0  lds
    buffer_load_dwordx4 v45, s[40:43], s33 offen offset:1024  lds
    buffer_load_dwordx4 v46, s[40:43], s33 offen offset:2048  lds
    buffer_load_dwordx4 v47, s[40:43], s33 offen offset:3072  lds
    s_add_u32 m0, s36, 0
    s_xor_b32 s33, s30, 0
    buffer_load_dwordx4 v4, s[52:55], s33 offen offset:0  lds
    buffer_load_dwordx4 v5, s[52:55], s33 offen offset:1024  lds
    buffer_load_dwordx4 v6, s[52:55], s33 offen offset:2048  lds
    buffer_load_dwordx4 v7, s[52:55], s33 offen offset:3072  lds
    s_add_u32 m0, s36, 16384
    s_xor_b32 s33, s30, 262144
    buffer_load_dwordx4 v4, s[52:55], s33 offen offset:0  lds
    buffer_load_dwordx4 v5, s[52:55], s33 offen offset:1024  lds
    buffer_load_dwordx4 v6, s[52:55], s33 offen offset:2048  lds
    buffer_load_dwordx4 v7, s[52:55], s33 offen offset:3072  lds
    s_waitcnt vmcnt(4) lgkmcnt(0)
    s_barrier
    v_mfma_f32_16x16x32_bf16 v[128:131], a[32:35], a[80:83], v[128:131]
    ds_read_b128 a[64:67], v28 offset:32768
    s_add_u32 m0, s37, 147456
    v_mfma_f32_16x16x32_bf16 v[136:139], a[32:35], a[84:87], v[136:139]
    ds_read_b128 a[68:71], v28 offset:34816
    s_xor_b32 s33, s29, 128
    v_mfma_f32_16x16x32_bf16 v[144:147], a[32:35], a[88:91], v[144:147]
    buffer_load_dwordx4 v44, s[40:43], s33 offen offset:0  lds
    v_mfma_f32_16x16x32_bf16 v[152:155], a[32:35], a[92:95], v[152:155]
    ds_read_b128 a[72:75], v28 offset:36864
    v_mfma_f32_16x16x32_bf16 v[156:159], a[36:39], a[92:95], v[156:159]
    ds_read_b128 a[76:79], v28 offset:38912
    v_mfma_f32_16x16x32_bf16 v[148:151], a[36:39], a[88:91], v[148:151]
    ds_read_b64_tr_b16 a[0:1], v48 offset:0
    v_mfma_f32_16x16x32_bf16 v[140:143], a[36:39], a[84:87], v[140:143]
    buffer_load_dwordx4 v45, s[40:43], s33 offen offset:1024  lds
    v_mfma_f32_16x16x32_bf16 v[132:135], a[36:39], a[80:83], v[132:135]
    ds_read_b64_tr_b16 a[2:3], v48 offset:4096
    v_mfma_f32_16x16x32_bf16 v[160:163], a[40:43], a[80:83], v[160:163]
    ds_read_b64_tr_b16 a[4:5], v49 offset:0
    v_mfma_f32_16x16x32_bf16 v[168:171], a[40:43], a[84:87], v[168:171]
    ds_read_b64_tr_b16 a[6:7], v49 offset:4096
    v_mfma_f32_16x16x32_bf16 v[176:179], a[40:43], a[88:91], v[176:179]
    buffer_load_dwordx4 v46, s[40:43], s33 offen offset:2048  lds
    v_mfma_f32_16x16x32_bf16 v[184:187], a[40:43], a[92:95], v[184:187]
    ds_read_b64_tr_b16 a[8:9], v50 offset:0
    v_mfma_f32_16x16x32_bf16 v[188:191], a[44:47], a[92:95], v[188:191]
    ds_read_b64_tr_b16 a[10:11], v50 offset:4096
    v_mfma_f32_16x16x32_bf16 v[180:183], a[44:47], a[88:91], v[180:183]
    ds_read_b64_tr_b16 a[12:13], v51 offset:0
    v_mfma_f32_16x16x32_bf16 v[172:175], a[44:47], a[84:87], v[172:175]
    buffer_load_dwordx4 v47, s[40:43], s33 offen offset:3072  lds
    s_add_u32 m0, s36, 32768
    v_mfma_f32_16x16x32_bf16 v[164:167], a[44:47], a[80:83], v[164:167]
    ds_read_b64_tr_b16 a[14:15], v51 offset:4096
    s_xor_b32 s33, s30, 524288
    v_mfma_f32_16x16x32_bf16 v[192:195], a[48:51], a[80:83], v[192:195]
    ds_read_b64_tr_b16 a[16:17], v52 offset:0
    v_mfma_f32_16x16x32_bf16 v[200:203], a[48:51], a[84:87], v[200:203]
    ds_read_b64_tr_b16 a[18:19], v52 offset:4096
    v_mfma_f32_16x16x32_bf16 v[208:211], a[48:51], a[88:91], v[208:211]
    buffer_load_dwordx4 v4, s[52:55], s33 offen offset:0  lds
    v_mfma_f32_16x16x32_bf16 v[216:219], a[48:51], a[92:95], v[216:219]
    ds_read_b64_tr_b16 a[20:21], v53 offset:0
    v_mfma_f32_16x16x32_bf16 v[220:223], a[52:55], a[92:95], v[220:223]
    ds_read_b64_tr_b16 a[22:23], v53 offset:4096
    v_mfma_f32_16x16x32_bf16 v[212:215], a[52:55], a[88:91], v[212:215]
    ds_read_b64_tr_b16 a[24:25], v54 offset:0
    v_mfma_f32_16x16x32_bf16 v[204:207], a[52:55], a[84:87], v[204:207]
    buffer_load_dwordx4 v5, s[52:55], s33 offen offset:1024  lds
    v_mfma_f32_16x16x32_bf16 v[196:199], a[52:55], a[80:83], v[196:199]
    ds_read_b64_tr_b16 a[26:27], v54 offset:4096
    v_mfma_f32_16x16x32_bf16 v[224:227], a[56:59], a[80:83], v[224:227]
    ds_read_b64_tr_b16 a[28:29], v55 offset:0
    v_mfma_f32_16x16x32_bf16 v[232:235], a[56:59], a[84:87], v[232:235]
    ds_read_b64_tr_b16 a[30:31], v55 offset:4096
    v_mfma_f32_16x16x32_bf16 v[240:243], a[56:59], a[88:91], v[240:243]
    buffer_load_dwordx4 v6, s[52:55], s33 offen offset:2048  lds
    v_mfma_f32_16x16x32_bf16 v[248:251], a[56:59], a[92:95], v[248:251]
    v_mfma_f32_16x16x32_bf16 v[252:255], a[60:63], a[92:95], v[252:255]
    v_mfma_f32_16x16x32_bf16 v[244:247], a[60:63], a[88:91], v[244:247]
    v_mfma_f32_16x16x32_bf16 v[236:239], a[60:63], a[84:87], v[236:239]
    buffer_load_dwordx4 v7, s[52:55], s33 offen offset:3072  lds
    v_mfma_f32_16x16x32_bf16 v[228:231], a[60:63], a[80:83], v[228:231]
    s_waitcnt vmcnt(8) lgkmcnt(0)
    s_barrier
    v_mfma_f32_16x16x32_bf16 v[128:131], a[0:3], a[64:67], v[128:131]
    ds_read_b128 a[80:83], v29 offset:32768
    s_add_u32 m0, s36, 49152
    v_mfma_f32_16x16x32_bf16 v[136:139], a[0:3], a[68:71], v[136:139]
    ds_read_b128 a[84:87], v29 offset:34816
    s_xor_b32 s33, s30, 786432
    v_mfma_f32_16x16x32_bf16 v[144:147], a[0:3], a[72:75], v[144:147]
    buffer_load_dwordx4 v4, s[52:55], s33 offen offset:0  lds
    v_mfma_f32_16x16x32_bf16 v[152:155], a[0:3], a[76:79], v[152:155]
    ds_read_b128 a[88:91], v29 offset:36864
    v_mfma_f32_16x16x32_bf16 v[156:159], a[4:7], a[76:79], v[156:159]
    ds_read_b128 a[92:95], v29 offset:38912
    v_mfma_f32_16x16x32_bf16 v[148:151], a[4:7], a[72:75], v[148:151]
    ds_read_b64_tr_b16 a[32:33], v48 offset:16384
    v_mfma_f32_16x16x32_bf16 v[140:143], a[4:7], a[68:71], v[140:143]
    buffer_load_dwordx4 v5, s[52:55], s33 offen offset:1024  lds
    v_mfma_f32_16x16x32_bf16 v[132:135], a[4:7], a[64:67], v[132:135]
    ds_read_b64_tr_b16 a[34:35], v48 offset:20480
    v_mfma_f32_16x16x32_bf16 v[160:163], a[8:11], a[64:67], v[160:163]
    ds_read_b64_tr_b16 a[36:37], v49 offset:16384
    v_mfma_f32_16x16x32_bf16 v[168:171], a[8:11], a[68:71], v[168:171]
    ds_read_b64_tr_b16 a[38:39], v49 offset:20480
    v_mfma_f32_16x16x32_bf16 v[176:179], a[8:11], a[72:75], v[176:179]
    buffer_load_dwordx4 v6, s[52:55], s33 offen offset:2048  lds
    v_mfma_f32_16x16x32_bf16 v[184:187], a[8:11], a[76:79], v[184:187]
    ds_read_b64_tr_b16 a[40:41], v50 offset:16384
    v_mfma_f32_16x16x32_bf16 v[188:191], a[12:15], a[76:79], v[188:191]
    ds_read_b64_tr_b16 a[42:43], v50 offset:20480
    v_mfma_f32_16x16x32_bf16 v[180:183], a[12:15], a[72:75], v[180:183]
    ds_read_b64_tr_b16 a[44:45], v51 offset:16384
    v_mfma_f32_16x16x32_bf16 v[172:175], a[12:15], a[68:71], v[172:175]
    buffer_load_dwordx4 v7, s[52:55], s33 offen offset:3072  lds
    s_add_u32 m0, s37, 98304
    v_mfma_f32_16x16x32_bf16 v[164:167], a[12:15], a[64:67], v[164:167]
    ds_read_b64_tr_b16 a[46:47], v51 offset:20480
    s_xor_b32 s33, s29, 768
    v_mfma_f32_16x16x32_bf16 v[192:195], a[16:19], a[64:67], v[192:195]
    ds_read_b64_tr_b16 a[48:49], v52 offset:16384
    v_mfma_f32_16x16x32_bf16 v[200:203], a[16:19], a[68:71], v[200:203]
    ds_read_b64_tr_b16 a[50:51], v52 offset:20480
    v_mfma_f32_16x16x32_bf16 v[208:211], a[16:19], a[72:75], v[208:211]
    buffer_load_dwordx4 v44, s[40:43], s33 offen offset:0  lds
    v_mfma_f32_16x16x32_bf16 v[216:219], a[16:19], a[76:79], v[216:219]
    ds_read_b64_tr_b16 a[52:53], v53 offset:16384
    v_mfma_f32_16x16x32_bf16 v[220:223], a[20:23], a[76:79], v[220:223]
    ds_read_b64_tr_b16 a[54:55], v53 offset:20480
    v_mfma_f32_16x16x32_bf16 v[212:215], a[20:23], a[72:75], v[212:215]
    ds_read_b64_tr_b16 a[56:57], v54 offset:16384
    v_mfma_f32_16x16x32_bf16 v[204:207], a[20:23], a[68:71], v[204:207]
    buffer_load_dwordx4 v45, s[40:43], s33 offen offset:1024  lds
    v_mfma_f32_16x16x32_bf16 v[196:199], a[20:23], a[64:67], v[196:199]
    ds_read_b64_tr_b16 a[58:59], v54 offset:20480
    v_mfma_f32_16x16x32_bf16 v[224:227], a[24:27], a[64:67], v[224:227]
    ds_read_b64_tr_b16 a[60:61], v55 offset:16384
    v_mfma_f32_16x16x32_bf16 v[232:235], a[24:27], a[68:71], v[232:235]
    ds_read_b64_tr_b16 a[62:63], v55 offset:20480
    v_mfma_f32_16x16x32_bf16 v[240:243], a[24:27], a[72:75], v[240:243]
    buffer_load_dwordx4 v46, s[40:43], s33 offen offset:2048  lds
    v_mfma_f32_16x16x32_bf16 v[248:251], a[24:27], a[76:79], v[248:251]
    v_mfma_f32_16x16x32_bf16 v[252:255], a[28:31], a[76:79], v[252:255]
    v_mfma_f32_16x16x32_bf16 v[244:247], a[28:31], a[72:75], v[244:247]
    v_mfma_f32_16x16x32_bf16 v[236:239], a[28:31], a[68:71], v[236:239]
    buffer_load_dwordx4 v47, s[40:43], s33 offen offset:3072  lds
    v_mfma_f32_16x16x32_bf16 v[228:231], a[28:31], a[64:67], v[228:231]
    s_waitcnt vmcnt(8) lgkmcnt(0)
    s_barrier
    v_mfma_f32_16x16x32_bf16 v[128:131], a[32:35], a[80:83], v[128:131]
    ds_read_b128 a[64:67], v28 offset:49152
    s_add_u32 m0, s36, 0
    v_mfma_f32_16x16x32_bf16 v[136:139], a[32:35], a[84:87], v[136:139]
    ds_read_b128 a[68:71], v28 offset:51200
    s_xor_b32 s33, s30, 3145728
    v_mfma_f32_16x16x32_bf16 v[144:147], a[32:35], a[88:91], v[144:147]
    buffer_load_dwordx4 v4, s[52:55], s33 offen offset:0  lds
    v_mfma_f32_16x16x32_bf16 v[152:155], a[32:35], a[92:95], v[152:155]
    ds_read_b128 a[72:75], v28 offset:53248
    ds_read_b128 a[76:79], v28 offset:55296
    v_mfma_f32_16x16x32_bf16 v[156:159], a[36:39], a[92:95], v[156:159]
    ds_read_b64_tr_b16 a[0:1], v48 offset:32768
    ds_read_b64_tr_b16 a[2:3], v48 offset:36864
    v_mfma_f32_16x16x32_bf16 v[148:151], a[36:39], a[88:91], v[148:151]
    ds_read_b64_tr_b16 a[4:5], v49 offset:32768
    ds_read_b64_tr_b16 a[6:7], v49 offset:36864
    v_mfma_f32_16x16x32_bf16 v[140:143], a[36:39], a[84:87], v[140:143]
    buffer_load_dwordx4 v5, s[52:55], s33 offen offset:1024  lds
    v_mfma_f32_16x16x32_bf16 v[132:135], a[36:39], a[80:83], v[132:135]
    ds_read_b64_tr_b16 a[8:9], v50 offset:32768
    ds_read_b64_tr_b16 a[10:11], v50 offset:36864
    v_mfma_f32_16x16x32_bf16 v[160:163], a[40:43], a[80:83], v[160:163]
    ds_read_b64_tr_b16 a[12:13], v51 offset:32768
    ds_read_b64_tr_b16 a[14:15], v51 offset:36864
    v_mfma_f32_16x16x32_bf16 v[168:171], a[40:43], a[84:87], v[168:171]
    ds_read_b64_tr_b16 a[16:17], v52 offset:32768
    ds_read_b64_tr_b16 a[18:19], v52 offset:36864
    v_mfma_f32_16x16x32_bf16 v[176:179], a[40:43], a[88:91], v[176:179]
    buffer_load_dwordx4 v6, s[52:55], s33 offen offset:2048  lds
    v_mfma_f32_16x16x32_bf16 v[184:187], a[40:43], a[92:95], v[184:187]
    ds_read_b64_tr_b16 a[20:21], v53 offset:32768
    ds_read_b64_tr_b16 a[22:23], v53 offset:36864
    v_mfma_f32_16x16x32_bf16 v[188:191], a[44:47], a[92:95], v[188:191]
    ds_read_b64_tr_b16 a[24:25], v54 offset:32768
    ds_read_b64_tr_b16 a[26:27], v54 offset:36864
    v_mfma_f32_16x16x32_bf16 v[180:183], a[44:47], a[88:91], v[180:183]
    ds_read_b64_tr_b16 a[28:29], v55 offset:32768
    ds_read_b64_tr_b16 a[30:31], v55 offset:36864
    v_mfma_f32_16x16x32_bf16 v[172:175], a[44:47], a[84:87], v[172:175]
    buffer_load_dwordx4 v7, s[52:55], s33 offen offset:3072  lds
    v_mfma_f32_16x16x32_bf16 v[164:167], a[44:47], a[80:83], v[164:167]
    ds_read_b64 a[160:161], v32 offset:0
    ds_read_b64 a[176:177], v32 offset:4096
    v_mfma_f32_16x16x32_bf16 v[192:195], a[48:51], a[80:83], v[192:195]
    ds_read_b64 a[162:163], v33 offset:0
    ds_read_b64 a[178:179], v33 offset:4096
    v_mfma_f32_16x16x32_bf16 v[200:203], a[48:51], a[84:87], v[200:203]
    ds_read_b64 a[164:165], v34 offset:0
    ds_read_b64 a[180:181], v34 offset:4096
    v_mfma_f32_16x16x32_bf16 v[208:211], a[48:51], a[88:91], v[208:211]
    ds_read_b64 a[166:167], v35 offset:0
    v_mfma_f32_16x16x32_bf16 v[216:219], a[48:51], a[92:95], v[216:219]
    ds_read_b64 a[182:183], v35 offset:4096
    v_mfma_f32_16x16x32_bf16 v[220:223], a[52:55], a[92:95], v[220:223]
    ds_read_b64 a[168:169], v36 offset:0
    v_mfma_f32_16x16x32_bf16 v[212:215], a[52:55], a[88:91], v[212:215]
    ds_read_b64 a[184:185], v36 offset:4096
    v_mfma_f32_16x16x32_bf16 v[204:207], a[52:55], a[84:87], v[204:207]
    ds_read_b64 a[170:171], v37 offset:0
    v_mfma_f32_16x16x32_bf16 v[196:199], a[52:55], a[80:83], v[196:199]
    ds_read_b64 a[186:187], v37 offset:4096
    v_mfma_f32_16x16x32_bf16 v[224:227], a[56:59], a[80:83], v[224:227]
    ds_read_b64 a[172:173], v38 offset:0
    v_mfma_f32_16x16x32_bf16 v[232:235], a[56:59], a[84:87], v[232:235]
    ds_read_b64 a[188:189], v38 offset:4096
    v_mfma_f32_16x16x32_bf16 v[240:243], a[56:59], a[88:91], v[240:243]
    ds_read_b64 a[174:175], v39 offset:0
    v_mfma_f32_16x16x32_bf16 v[248:251], a[56:59], a[92:95], v[248:251]
    ds_read_b64 a[190:191], v39 offset:4096
    v_mfma_f32_16x16x32_bf16 v[252:255], a[60:63], a[92:95], v[252:255]
    v_mfma_f32_16x16x32_bf16 v[244:247], a[60:63], a[88:91], v[244:247]
    v_mfma_f32_16x16x32_bf16 v[236:239], a[60:63], a[84:87], v[236:239]
    v_mfma_f32_16x16x32_bf16 v[228:231], a[60:63], a[80:83], v[228:231]
    s_waitcnt vmcnt(8) lgkmcnt(0)
    s_barrier
    v_mfma_f32_16x16x32_bf16 v[128:131], a[0:3], a[64:67], v[128:131]
    ds_read_b128 a[80:83], v29 offset:49152
    v_mfma_f32_16x16x32_bf16 v[136:139], a[0:3], a[68:71], v[136:139]
    ds_read_b128 a[84:87], v29 offset:51200
    v_mfma_f32_16x16x32_bf16 v[144:147], a[0:3], a[72:75], v[144:147]
    ds_read_b128 a[88:91], v29 offset:53248
    v_mfma_f32_16x16x32_bf16 v[152:155], a[0:3], a[76:79], v[152:155]
    ds_read_b128 a[92:95], v29 offset:55296
    v_mfma_f32_16x16x32_bf16 v[156:159], a[4:7], a[76:79], v[156:159]
    ds_read_b64_tr_b16 a[32:33], v48 offset:49152
    v_mfma_f32_16x16x32_bf16 v[148:151], a[4:7], a[72:75], v[148:151]
    ds_read_b64_tr_b16 a[34:35], v48 offset:53248
    v_mfma_f32_16x16x32_bf16 v[140:143], a[4:7], a[68:71], v[140:143]
    ds_read_b64_tr_b16 a[36:37], v49 offset:49152
    v_mfma_f32_16x16x32_bf16 v[132:135], a[4:7], a[64:67], v[132:135]
    ds_read_b64_tr_b16 a[38:39], v49 offset:53248
    v_mfma_f32_16x16x32_bf16 v[160:163], a[8:11], a[64:67], v[160:163]
    ds_read_b64_tr_b16 a[40:41], v50 offset:49152
    v_mfma_f32_16x16x32_bf16 v[168:171], a[8:11], a[68:71], v[168:171]
    ds_read_b64_tr_b16 a[42:43], v50 offset:53248
    v_mfma_f32_16x16x32_bf16 v[176:179], a[8:11], a[72:75], v[176:179]
    ds_read_b64_tr_b16 a[44:45], v51 offset:49152
    v_mfma_f32_16x16x32_bf16 v[184:187], a[8:11], a[76:79], v[184:187]
    ds_read_b64_tr_b16 a[46:47], v51 offset:53248
    v_mfma_f32_16x16x32_bf16 v[188:191], a[12:15], a[76:79], v[188:191]
    ds_read_b64_tr_b16 a[48:49], v52 offset:49152
    v_mfma_f32_16x16x32_bf16 v[180:183], a[12:15], a[72:75], v[180:183]
    ds_read_b64_tr_b16 a[50:51], v52 offset:53248
    v_mfma_f32_16x16x32_bf16 v[172:175], a[12:15], a[68:71], v[172:175]
    ds_read_b64_tr_b16 a[52:53], v53 offset:49152
    v_mfma_f32_16x16x32_bf16 v[164:167], a[12:15], a[64:67], v[164:167]
    ds_read_b64_tr_b16 a[54:55], v53 offset:53248
    v_mfma_f32_16x16x32_bf16 v[192:195], a[16:19], a[64:67], v[192:195]
    ds_read_b64_tr_b16 a[56:57], v54 offset:49152
    v_mfma_f32_16x16x32_bf16 v[200:203], a[16:19], a[68:71], v[200:203]
    ds_read_b64_tr_b16 a[58:59], v54 offset:53248
    v_mfma_f32_16x16x32_bf16 v[208:211], a[16:19], a[72:75], v[208:211]
    ds_read_b64_tr_b16 a[60:61], v55 offset:49152
    v_mfma_f32_16x16x32_bf16 v[216:219], a[16:19], a[76:79], v[216:219]
    ds_read_b64_tr_b16 a[62:63], v55 offset:53248
    v_mfma_f32_16x16x32_bf16 v[220:223], a[20:23], a[76:79], v[220:223]
    v_mfma_f32_16x16x32_bf16 v[212:215], a[20:23], a[72:75], v[212:215]
    v_mfma_f32_16x16x32_bf16 v[204:207], a[20:23], a[68:71], v[204:207]
    v_mfma_f32_16x16x32_bf16 v[196:199], a[20:23], a[64:67], v[196:199]
    v_mfma_f32_16x16x32_bf16 v[224:227], a[24:27], a[64:67], v[224:227]
    v_mfma_f32_16x16x32_bf16 v[232:235], a[24:27], a[68:71], v[232:235]
    v_mfma_f32_16x16x32_bf16 v[240:243], a[24:27], a[72:75], v[240:243]
    v_mfma_f32_16x16x32_bf16 v[248:251], a[24:27], a[76:79], v[248:251]
    v_mfma_f32_16x16x32_bf16 v[252:255], a[28:31], a[76:79], v[252:255]
    v_mfma_f32_16x16x32_bf16 v[244:247], a[28:31], a[72:75], v[244:247]
    v_mfma_f32_16x16x32_bf16 v[236:239], a[28:31], a[68:71], v[236:239]
    v_mfma_f32_16x16x32_bf16 v[228:231], a[28:31], a[64:67], v[228:231]
    s_waitcnt vmcnt(0) lgkmcnt(0)
    s_barrier
    v_mfma_f32_16x16x32_bf16 v[128:131], a[32:35], a[80:83], v[128:131]
    ds_read_b128 a[64:67], v28 offset:0
    s_add_u32 m0, s36, 16384
    v_mfma_f32_16x16x32_bf16 v[136:139], a[32:35], a[84:87], v[136:139]
    ds_read_b128 a[68:71], v28 offset:2048
    s_xor_b32 s33, s30, 3407872
    v_mfma_f32_16x16x32_bf16 v[144:147], a[32:35], a[88:91], v[144:147]
    buffer_load_dwordx4 v4, s[52:55], s33 offen offset:0  lds
    v_mfma_f32_16x16x32_bf16 v[152:155], a[32:35], a[92:95], v[152:155]
    ds_read_b128 a[72:75], v28 offset:4096
    v_mfma_f32_16x16x32_bf16 v[156:159], a[36:39], a[92:95], v[156:159]
    ds_read_b128 a[76:79], v28 offset:6144
    v_mfma_f32_16x16x32_bf16 v[148:151], a[36:39], a[88:91], v[148:151]
    ds_read_b64_tr_b16 a[0:1], v48 offset:0
    v_mfma_f32_16x16x32_bf16 v[140:143], a[36:39], a[84:87], v[140:143]
    buffer_load_dwordx4 v5, s[52:55], s33 offen offset:1024  lds
    v_mfma_f32_16x16x32_bf16 v[132:135], a[36:39], a[80:83], v[132:135]
    ds_read_b64_tr_b16 a[2:3], v48 offset:4096
    v_mfma_f32_16x16x32_bf16 v[160:163], a[40:43], a[80:83], v[160:163]
    ds_read_b64_tr_b16 a[4:5], v49 offset:0
    v_mfma_f32_16x16x32_bf16 v[168:171], a[40:43], a[84:87], v[168:171]
    ds_read_b64_tr_b16 a[6:7], v49 offset:4096
    v_mfma_f32_16x16x32_bf16 v[176:179], a[40:43], a[88:91], v[176:179]
    buffer_load_dwordx4 v6, s[52:55], s33 offen offset:2048  lds
    v_mfma_f32_16x16x32_bf16 v[184:187], a[40:43], a[92:95], v[184:187]
    ds_read_b64_tr_b16 a[8:9], v50 offset:0
    v_mfma_f32_16x16x32_bf16 v[188:191], a[44:47], a[92:95], v[188:191]
    ds_read_b64_tr_b16 a[10:11], v50 offset:4096
    v_mfma_f32_16x16x32_bf16 v[180:183], a[44:47], a[88:91], v[180:183]
    ds_read_b64_tr_b16 a[12:13], v51 offset:0
    v_mfma_f32_16x16x32_bf16 v[172:175], a[44:47], a[84:87], v[172:175]
    buffer_load_dwordx4 v7, s[52:55], s33 offen offset:3072  lds
    s_add_u32 m0, s37, 114688
    v_mfma_f32_16x16x32_bf16 v[164:167], a[44:47], a[80:83], v[164:167]
    ds_read_b64_tr_b16 a[14:15], v51 offset:4096
    s_xor_b32 s33, s29, 896
    v_mfma_f32_16x16x32_bf16 v[192:195], a[48:51], a[80:83], v[192:195]
    ds_read_b64_tr_b16 a[16:17], v52 offset:0
    v_mfma_f32_16x16x32_bf16 v[200:203], a[48:51], a[84:87], v[200:203]
    ds_read_b64_tr_b16 a[18:19], v52 offset:4096
    v_mfma_f32_16x16x32_bf16 v[208:211], a[48:51], a[88:91], v[208:211]
    buffer_load_dwordx4 v44, s[40:43], s33 offen offset:0  lds
    v_mfma_f32_16x16x32_bf16 v[216:219], a[48:51], a[92:95], v[216:219]
    ds_read_b64_tr_b16 a[20:21], v53 offset:0
    v_mfma_f32_16x16x32_bf16 v[220:223], a[52:55], a[92:95], v[220:223]
    ds_read_b64_tr_b16 a[22:23], v53 offset:4096
    v_mfma_f32_16x16x32_bf16 v[212:215], a[52:55], a[88:91], v[212:215]
    ds_read_b64_tr_b16 a[24:25], v54 offset:0
    v_mfma_f32_16x16x32_bf16 v[204:207], a[52:55], a[84:87], v[204:207]
    buffer_load_dwordx4 v45, s[40:43], s33 offen offset:1024  lds
    v_mfma_f32_16x16x32_bf16 v[196:199], a[52:55], a[80:83], v[196:199]
    ds_read_b64_tr_b16 a[26:27], v54 offset:4096
    v_mfma_f32_16x16x32_bf16 v[224:227], a[56:59], a[80:83], v[224:227]
    ds_read_b64_tr_b16 a[28:29], v55 offset:0
    v_mfma_f32_16x16x32_bf16 v[232:235], a[56:59], a[84:87], v[232:235]
    ds_read_b64_tr_b16 a[30:31], v55 offset:4096
    v_mfma_f32_16x16x32_bf16 v[240:243], a[56:59], a[88:91], v[240:243]
    buffer_load_dwordx4 v46, s[40:43], s33 offen offset:2048  lds
    v_mfma_f32_16x16x32_bf16 v[248:251], a[56:59], a[92:95], v[248:251]
    v_mfma_f32_16x16x32_bf16 v[252:255], a[60:63], a[92:95], v[252:255]
    v_mfma_f32_16x16x32_bf16 v[244:247], a[60:63], a[88:91], v[244:247]
    v_mfma_f32_16x16x32_bf16 v[236:239], a[60:63], a[84:87], v[236:239]
    buffer_load_dwordx4 v47, s[40:43], s33 offen offset:3072  lds
    v_mfma_f32_16x16x32_bf16 v[228:231], a[60:63], a[80:83], v[228:231]
    s_waitcnt vmcnt(4) lgkmcnt(0)
    s_barrier
    v_mfma_f32_16x16x32_bf16 v[128:131], a[0:3], a[64:67], v[128:131]
    ds_read_b128 a[80:83], v29 offset:0
    s_add_u32 m0, s36, 32768
    v_mfma_f32_16x16x32_bf16 v[136:139], a[0:3], a[68:71], v[136:139]
    ds_read_b128 a[84:87], v29 offset:2048
    s_xor_b32 s33, s30, 3670016
    v_mfma_f32_16x16x32_bf16 v[144:147], a[0:3], a[72:75], v[144:147]
    buffer_load_dwordx4 v4, s[52:55], s33 offen offset:0  lds
    v_mfma_f32_16x16x32_bf16 v[152:155], a[0:3], a[76:79], v[152:155]
    ds_read_b128 a[88:91], v29 offset:4096
    v_mfma_f32_16x16x32_bf16 v[156:159], a[4:7], a[76:79], v[156:159]
    ds_read_b128 a[92:95], v29 offset:6144
    v_mfma_f32_16x16x32_bf16 v[148:151], a[4:7], a[72:75], v[148:151]
    ds_read_b64_tr_b16 a[32:33], v48 offset:16384
    v_mfma_f32_16x16x32_bf16 v[140:143], a[4:7], a[68:71], v[140:143]
    buffer_load_dwordx4 v5, s[52:55], s33 offen offset:1024  lds
    v_mfma_f32_16x16x32_bf16 v[132:135], a[4:7], a[64:67], v[132:135]
    ds_read_b64_tr_b16 a[34:35], v48 offset:20480
    v_mfma_f32_16x16x32_bf16 v[160:163], a[8:11], a[64:67], v[160:163]
    ds_read_b64_tr_b16 a[36:37], v49 offset:16384
    v_mfma_f32_16x16x32_bf16 v[168:171], a[8:11], a[68:71], v[168:171]
    ds_read_b64_tr_b16 a[38:39], v49 offset:20480
    v_mfma_f32_16x16x32_bf16 v[176:179], a[8:11], a[72:75], v[176:179]
    buffer_load_dwordx4 v6, s[52:55], s33 offen offset:2048  lds
    v_mfma_f32_16x16x32_bf16 v[184:187], a[8:11], a[76:79], v[184:187]
    ds_read_b64_tr_b16 a[40:41], v50 offset:16384
    v_mfma_f32_16x16x32_bf16 v[188:191], a[12:15], a[76:79], v[188:191]
    ds_read_b64_tr_b16 a[42:43], v50 offset:20480
    v_mfma_f32_16x16x32_bf16 v[180:183], a[12:15], a[72:75], v[180:183]
    ds_read_b64_tr_b16 a[44:45], v51 offset:16384
    v_mfma_f32_16x16x32_bf16 v[172:175], a[12:15], a[68:71], v[172:175]
    buffer_load_dwordx4 v7, s[52:55], s33 offen offset:3072  lds
    s_add_u32 m0, s36, 49152
    v_mfma_f32_16x16x32_bf16 v[164:167], a[12:15], a[64:67], v[164:167]
    ds_read_b64_tr_b16 a[46:47], v51 offset:20480
    s_xor_b32 s33, s30, 3932160
    v_mfma_f32_16x16x32_bf16 v[192:195], a[16:19], a[64:67], v[192:195]
    ds_read_b64_tr_b16 a[48:49], v52 offset:16384
    v_mfma_f32_16x16x32_bf16 v[200:203], a[16:19], a[68:71], v[200:203]
    ds_read_b64_tr_b16 a[50:51], v52 offset:20480
    v_mfma_f32_16x16x32_bf16 v[208:211], a[16:19], a[72:75], v[208:211]
    buffer_load_dwordx4 v4, s[52:55], s33 offen offset:0  lds
    v_mfma_f32_16x16x32_bf16 v[216:219], a[16:19], a[76:79], v[216:219]
    ds_read_b64_tr_b16 a[52:53], v53 offset:16384
    v_mfma_f32_16x16x32_bf16 v[220:223], a[20:23], a[76:79], v[220:223]
    ds_read_b64_tr_b16 a[54:55], v53 offset:20480
    v_mfma_f32_16x16x32_bf16 v[212:215], a[20:23], a[72:75], v[212:215]
    ds_read_b64_tr_b16 a[56:57], v54 offset:16384
    v_mfma_f32_16x16x32_bf16 v[204:207], a[20:23], a[68:71], v[204:207]
    buffer_load_dwordx4 v5, s[52:55], s33 offen offset:1024  lds
    v_mfma_f32_16x16x32_bf16 v[196:199], a[20:23], a[64:67], v[196:199]
    ds_read_b64_tr_b16 a[58:59], v54 offset:20480
    v_mfma_f32_16x16x32_bf16 v[224:227], a[24:27], a[64:67], v[224:227]
    ds_read_b64_tr_b16 a[60:61], v55 offset:16384
    v_mfma_f32_16x16x32_bf16 v[232:235], a[24:27], a[68:71], v[232:235]
    ds_read_b64_tr_b16 a[62:63], v55 offset:20480
    v_mfma_f32_16x16x32_bf16 v[240:243], a[24:27], a[72:75], v[240:243]
    buffer_load_dwordx4 v6, s[52:55], s33 offen offset:2048  lds
    v_mfma_f32_16x16x32_bf16 v[248:251], a[24:27], a[76:79], v[248:251]
    v_mfma_f32_16x16x32_bf16 v[252:255], a[28:31], a[76:79], v[252:255]
    v_mfma_f32_16x16x32_bf16 v[244:247], a[28:31], a[72:75], v[244:247]
    v_mfma_f32_16x16x32_bf16 v[236:239], a[28:31], a[68:71], v[236:239]
    buffer_load_dwordx4 v7, s[52:55], s33 offen offset:3072  lds
    v_mfma_f32_16x16x32_bf16 v[228:231], a[28:31], a[64:67], v[228:231]
    s_waitcnt vmcnt(4) lgkmcnt(0)
    s_barrier
    v_mfma_f32_16x16x32_bf16 v[128:131], a[32:35], a[80:83], v[128:131]
    ds_read_b128 a[64:67], v28 offset:16384
    s_add_u32 m0, s37, 131072
    v_mfma_f32_16x16x32_bf16 v[136:139], a[32:35], a[84:87], v[136:139]
    ds_read_b128 a[68:71], v28 offset:18432
    s_xor_b32 s33, s29, 512
    v_mfma_f32_16x16x32_bf16 v[144:147], a[32:35], a[88:91], v[144:147]
    buffer_load_dwordx4 v44, s[40:43], s33 offen offset:0  lds
    v_mfma_f32_16x16x32_bf16 v[152:155], a[32:35], a[92:95], v[152:155]
    ds_read_b128 a[72:75], v28 offset:20480
    v_mfma_f32_16x16x32_bf16 v[156:159], a[36:39], a[92:95], v[156:159]
    ds_read_b128 a[76:79], v28 offset:22528
    v_mfma_f32_16x16x32_bf16 v[148:151], a[36:39], a[88:91], v[148:151]
    ds_read_b64_tr_b16 a[0:1], v48 offset:32768
    v_mfma_f32_16x16x32_bf16 v[140:143], a[36:39], a[84:87], v[140:143]
    buffer_load_dwordx4 v45, s[40:43], s33 offen offset:1024  lds
    v_mfma_f32_16x16x32_bf16 v[132:135], a[36:39], a[80:83], v[132:135]
    ds_read_b64_tr_b16 a[2:3], v48 offset:36864
    v_mfma_f32_16x16x32_bf16 v[160:163], a[40:43], a[80:83], v[160:163]
    ds_read_b64_tr_b16 a[4:5], v49 offset:32768
    v_mfma_f32_16x16x32_bf16 v[168:171], a[40:43], a[84:87], v[168:171]
    ds_read_b64_tr_b16 a[6:7], v49 offset:36864
    v_mfma_f32_16x16x32_bf16 v[176:179], a[40:43], a[88:91], v[176:179]
    buffer_load_dwordx4 v46, s[40:43], s33 offen offset:2048  lds
    v_mfma_f32_16x16x32_bf16 v[184:187], a[40:43], a[92:95], v[184:187]
    ds_read_b64_tr_b16 a[8:9], v50 offset:32768
    v_mfma_f32_16x16x32_bf16 v[188:191], a[44:47], a[92:95], v[188:191]
    ds_read_b64_tr_b16 a[10:11], v50 offset:36864
    v_mfma_f32_16x16x32_bf16 v[180:183], a[44:47], a[88:91], v[180:183]
    ds_read_b64_tr_b16 a[12:13], v51 offset:32768
    v_mfma_f32_16x16x32_bf16 v[172:175], a[44:47], a[84:87], v[172:175]
    buffer_load_dwordx4 v47, s[40:43], s33 offen offset:3072  lds
    s_add_u32 m0, s36, 0
    v_mfma_f32_16x16x32_bf16 v[164:167], a[44:47], a[80:83], v[164:167]
    ds_read_b64_tr_b16 a[14:15], v51 offset:36864
    s_xor_b32 s33, s30, 2097152
    v_mfma_f32_16x16x32_bf16 v[192:195], a[48:51], a[80:83], v[192:195]
    ds_read_b64_tr_b16 a[16:17], v52 offset:32768
    v_mfma_f32_16x16x32_bf16 v[200:203], a[48:51], a[84:87], v[200:203]
    ds_read_b64_tr_b16 a[18:19], v52 offset:36864
    v_mfma_f32_16x16x32_bf16 v[208:211], a[48:51], a[88:91], v[208:211]
    buffer_load_dwordx4 v4, s[52:55], s33 offen offset:0  lds
    v_mfma_f32_16x16x32_bf16 v[216:219], a[48:51], a[92:95], v[216:219]
    ds_read_b64_tr_b16 a[20:21], v53 offset:32768
    v_mfma_f32_16x16x32_bf16 v[220:223], a[52:55], a[92:95], v[220:223]
    ds_read_b64_tr_b16 a[22:23], v53 offset:36864
    v_mfma_f32_16x16x32_bf16 v[212:215], a[52:55], a[88:91], v[212:215]
    ds_read_b64_tr_b16 a[24:25], v54 offset:32768
    v_mfma_f32_16x16x32_bf16 v[204:207], a[52:55], a[84:87], v[204:207]
    buffer_load_dwordx4 v5, s[52:55], s33 offen offset:1024  lds
    v_mfma_f32_16x16x32_bf16 v[196:199], a[52:55], a[80:83], v[196:199]
    ds_read_b64_tr_b16 a[26:27], v54 offset:36864
    v_mfma_f32_16x16x32_bf16 v[224:227], a[56:59], a[80:83], v[224:227]
    ds_read_b64_tr_b16 a[28:29], v55 offset:32768
    v_mfma_f32_16x16x32_bf16 v[232:235], a[56:59], a[84:87], v[232:235]
    ds_read_b64_tr_b16 a[30:31], v55 offset:36864
    v_mfma_f32_16x16x32_bf16 v[240:243], a[56:59], a[88:91], v[240:243]
    buffer_load_dwordx4 v6, s[52:55], s33 offen offset:2048  lds
    v_mfma_f32_16x16x32_bf16 v[248:251], a[56:59], a[92:95], v[248:251]
    v_mfma_f32_16x16x32_bf16 v[252:255], a[60:63], a[92:95], v[252:255]
    v_mfma_f32_16x16x32_bf16 v[244:247], a[60:63], a[88:91], v[244:247]
    v_mfma_f32_16x16x32_bf16 v[236:239], a[60:63], a[84:87], v[236:239]
    buffer_load_dwordx4 v7, s[52:55], s33 offen offset:3072  lds
    v_mfma_f32_16x16x32_bf16 v[228:231], a[60:63], a[80:83], v[228:231]
    s_waitcnt vmcnt(8) lgkmcnt(0)
    s_barrier
    v_mfma_f32_16x16x32_bf16 v[128:131], a[0:3], a[64:67], v[128:131]
    ds_read_b128 a[80:83], v29 offset:16384
    s_add_u32 m0, s36, 16384
    v_mfma_f32_16x16x32_bf16 v[136:139], a[0:3], a[68:71], v[136:139]
    ds_read_b128 a[84:87], v29 offset:18432
    s_xor_b32 s33, s30, 2359296
    v_mfma_f32_16x16x32_bf16 v[144:147], a[0:3], a[72:75], v[144:147]
    buffer_load_dwordx4 v4, s[52:55], s33 offen offset:0  lds
    v_mfma_f32_16x16x32_bf16 v[152:155], a[0:3], a[76:79], v[152:155]
    ds_read_b128 a[88:91], v29 offset:20480
    v_mfma_f32_16x16x32_bf16 v[156:159], a[4:7], a[76:79], v[156:159]
    ds_read_b128 a[92:95], v29 offset:22528
    v_mfma_f32_16x16x32_bf16 v[148:151], a[4:7], a[72:75], v[148:151]
    ds_read_b64_tr_b16 a[32:33], v48 offset:49152
    v_mfma_f32_16x16x32_bf16 v[140:143], a[4:7], a[68:71], v[140:143]
    buffer_load_dwordx4 v5, s[52:55], s33 offen offset:1024  lds
    v_mfma_f32_16x16x32_bf16 v[132:135], a[4:7], a[64:67], v[132:135]
    ds_read_b64_tr_b16 a[34:35], v48 offset:53248
    v_mfma_f32_16x16x32_bf16 v[160:163], a[8:11], a[64:67], v[160:163]
    ds_read_b64_tr_b16 a[36:37], v49 offset:49152
    v_mfma_f32_16x16x32_bf16 v[168:171], a[8:11], a[68:71], v[168:171]
    ds_read_b64_tr_b16 a[38:39], v49 offset:53248
    v_mfma_f32_16x16x32_bf16 v[176:179], a[8:11], a[72:75], v[176:179]
    buffer_load_dwordx4 v6, s[52:55], s33 offen offset:2048  lds
    v_mfma_f32_16x16x32_bf16 v[184:187], a[8:11], a[76:79], v[184:187]
    ds_read_b64_tr_b16 a[40:41], v50 offset:49152
    v_mfma_f32_16x16x32_bf16 v[188:191], a[12:15], a[76:79], v[188:191]
    ds_read_b64_tr_b16 a[42:43], v50 offset:53248
    v_mfma_f32_16x16x32_bf16 v[180:183], a[12:15], a[72:75], v[180:183]
    ds_read_b64_tr_b16 a[44:45], v51 offset:49152
    v_mfma_f32_16x16x32_bf16 v[172:175], a[12:15], a[68:71], v[172:175]
    buffer_load_dwordx4 v7, s[52:55], s33 offen offset:3072  lds
    s_add_u32 m0, s37, 147456
    v_mfma_f32_16x16x32_bf16 v[164:167], a[12:15], a[64:67], v[164:167]
    ds_read_b64_tr_b16 a[46:47], v51 offset:53248
    s_xor_b32 s33, s29, 640
    v_mfma_f32_16x16x32_bf16 v[192:195], a[16:19], a[64:67], v[192:195]
    ds_read_b64_tr_b16 a[48:49], v52 offset:49152
    v_mfma_f32_16x16x32_bf16 v[200:203], a[16:19], a[68:71], v[200:203]
    ds_read_b64_tr_b16 a[50:51], v52 offset:53248
    v_mfma_f32_16x16x32_bf16 v[208:211], a[16:19], a[72:75], v[208:211]
    buffer_load_dwordx4 v44, s[40:43], s33 offen offset:0  lds
    v_mfma_f32_16x16x32_bf16 v[216:219], a[16:19], a[76:79], v[216:219]
    ds_read_b64_tr_b16 a[52:53], v53 offset:49152
    v_mfma_f32_16x16x32_bf16 v[220:223], a[20:23], a[76:79], v[220:223]
    ds_read_b64_tr_b16 a[54:55], v53 offset:53248
    v_mfma_f32_16x16x32_bf16 v[212:215], a[20:23], a[72:75], v[212:215]
    ds_read_b64_tr_b16 a[56:57], v54 offset:49152
    v_mfma_f32_16x16x32_bf16 v[204:207], a[20:23], a[68:71], v[204:207]
    buffer_load_dwordx4 v45, s[40:43], s33 offen offset:1024  lds
    v_mfma_f32_16x16x32_bf16 v[196:199], a[20:23], a[64:67], v[196:199]
    ds_read_b64_tr_b16 a[58:59], v54 offset:53248
    v_mfma_f32_16x16x32_bf16 v[224:227], a[24:27], a[64:67], v[224:227]
    ds_read_b64_tr_b16 a[60:61], v55 offset:49152
    v_mfma_f32_16x16x32_bf16 v[232:235], a[24:27], a[68:71], v[232:235]
    ds_read_b64_tr_b16 a[62:63], v55 offset:53248
    v_mfma_f32_16x16x32_bf16 v[240:243], a[24:27], a[72:75], v[240:243]
    buffer_load_dwordx4 v46, s[40:43], s33 offen offset:2048  lds
    v_mfma_f32_16x16x32_bf16 v[248:251], a[24:27], a[76:79], v[248:251]
    v_mfma_f32_16x16x32_bf16 v[252:255], a[28:31], a[76:79], v[252:255]
    v_mfma_f32_16x16x32_bf16 v[244:247], a[28:31], a[72:75], v[244:247]
    v_mfma_f32_16x16x32_bf16 v[236:239], a[28:31], a[68:71], v[236:239]
    buffer_load_dwordx4 v47, s[40:43], s33 offen offset:3072  lds
    v_mfma_f32_16x16x32_bf16 v[228:231], a[28:31], a[64:67], v[228:231]
    s_waitcnt vmcnt(8) lgkmcnt(0)
    s_barrier
    v_mfma_f32_16x16x32_bf16 v[128:131], a[32:35], a[80:83], v[128:131]
    ds_read_b128 a[64:67], v28 offset:32768
    s_add_u32 m0, s36, 32768
    v_mfma_f32_16x16x32_bf16 v[136:139], a[32:35], a[84:87], v[136:139]
    ds_read_b128 a[68:71], v28 offset:34816
    s_xor_b32 s33, s30, 2621440
    v_mfma_f32_16x16x32_bf16 v[144:147], a[32:35], a[88:91], v[144:147]
    buffer_load_dwordx4 v4, s[52:55], s33 offen offset:0  lds
    v_mfma_f32_16x16x32_bf16 v[152:155], a[32:35], a[92:95], v[152:155]
    ds_read_b128 a[72:75], v28 offset:36864
    v_mfma_f32_16x16x32_bf16 v[156:159], a[36:39], a[92:95], v[156:159]
    ds_read_b128 a[76:79], v28 offset:38912
    v_mfma_f32_16x16x32_bf16 v[148:151], a[36:39], a[88:91], v[148:151]
    ds_read_b64_tr_b16 a[0:1], v48 offset:0
    v_mfma_f32_16x16x32_bf16 v[140:143], a[36:39], a[84:87], v[140:143]
    buffer_load_dwordx4 v5, s[52:55], s33 offen offset:1024  lds
    v_mfma_f32_16x16x32_bf16 v[132:135], a[36:39], a[80:83], v[132:135]
    ds_read_b64_tr_b16 a[2:3], v48 offset:4096
    v_mfma_f32_16x16x32_bf16 v[160:163], a[40:43], a[80:83], v[160:163]
    ds_read_b64_tr_b16 a[4:5], v49 offset:0
    v_mfma_f32_16x16x32_bf16 v[168:171], a[40:43], a[84:87], v[168:171]
    ds_read_b64_tr_b16 a[6:7], v49 offset:4096
    v_mfma_f32_16x16x32_bf16 v[176:179], a[40:43], a[88:91], v[176:179]
    buffer_load_dwordx4 v6, s[52:55], s33 offen offset:2048  lds
    v_mfma_f32_16x16x32_bf16 v[184:187], a[40:43], a[92:95], v[184:187]
    ds_read_b64_tr_b16 a[8:9], v50 offset:0
    v_mfma_f32_16x16x32_bf16 v[188:191], a[44:47], a[92:95], v[188:191]
    ds_read_b64_tr_b16 a[10:11], v50 offset:4096
    v_mfma_f32_16x16x32_bf16 v[180:183], a[44:47], a[88:91], v[180:183]
    ds_read_b64_tr_b16 a[12:13], v51 offset:0
    v_mfma_f32_16x16x32_bf16 v[172:175], a[44:47], a[84:87], v[172:175]
    buffer_load_dwordx4 v7, s[52:55], s33 offen offset:3072  lds
    s_add_u32 m0, s36, 49152
    v_mfma_f32_16x16x32_bf16 v[164:167], a[44:47], a[80:83], v[164:167]
    ds_read_b64_tr_b16 a[14:15], v51 offset:4096
    s_xor_b32 s33, s30, 2883584
    v_mfma_f32_16x16x32_bf16 v[192:195], a[48:51], a[80:83], v[192:195]
    ds_read_b64_tr_b16 a[16:17], v52 offset:0
    v_mfma_f32_16x16x32_bf16 v[200:203], a[48:51], a[84:87], v[200:203]
    ds_read_b64_tr_b16 a[18:19], v52 offset:4096
    v_mfma_f32_16x16x32_bf16 v[208:211], a[48:51], a[88:91], v[208:211]
    buffer_load_dwordx4 v4, s[52:55], s33 offen offset:0  lds
    v_mfma_f32_16x16x32_bf16 v[216:219], a[48:51], a[92:95], v[216:219]
    ds_read_b64_tr_b16 a[20:21], v53 offset:0
    v_mfma_f32_16x16x32_bf16 v[220:223], a[52:55], a[92:95], v[220:223]
    ds_read_b64_tr_b16 a[22:23], v53 offset:4096
    v_mfma_f32_16x16x32_bf16 v[212:215], a[52:55], a[88:91], v[212:215]
    ds_read_b64_tr_b16 a[24:25], v54 offset:0
    v_mfma_f32_16x16x32_bf16 v[204:207], a[52:55], a[84:87], v[204:207]
    buffer_load_dwordx4 v5, s[52:55], s33 offen offset:1024  lds
    v_mfma_f32_16x16x32_bf16 v[196:199], a[52:55], a[80:83], v[196:199]
    ds_read_b64_tr_b16 a[26:27], v54 offset:4096
    v_mfma_f32_16x16x32_bf16 v[224:227], a[56:59], a[80:83], v[224:227]
    ds_read_b64_tr_b16 a[28:29], v55 offset:0
    v_mfma_f32_16x16x32_bf16 v[232:235], a[56:59], a[84:87], v[232:235]
    ds_read_b64_tr_b16 a[30:31], v55 offset:4096
    v_mfma_f32_16x16x32_bf16 v[240:243], a[56:59], a[88:91], v[240:243]
    buffer_load_dwordx4 v6, s[52:55], s33 offen offset:2048  lds
    v_mfma_f32_16x16x32_bf16 v[248:251], a[56:59], a[92:95], v[248:251]
    v_mfma_f32_16x16x32_bf16 v[252:255], a[60:63], a[92:95], v[252:255]
    v_mfma_f32_16x16x32_bf16 v[244:247], a[60:63], a[88:91], v[244:247]
    v_mfma_f32_16x16x32_bf16 v[236:239], a[60:63], a[84:87], v[236:239]
    buffer_load_dwordx4 v7, s[52:55], s33 offen offset:3072  lds
    v_mfma_f32_16x16x32_bf16 v[228:231], a[60:63], a[80:83], v[228:231]
    s_waitcnt vmcnt(12) lgkmcnt(0)
    s_barrier
    v_mfma_f32_16x16x32_bf16 v[128:131], a[0:3], a[64:67], v[128:131]
    ds_read_b128 a[80:83], v29 offset:32768
    s_add_u32 m0, s37, 0
    v_mfma_f32_16x16x32_bf16 v[136:139], a[0:3], a[68:71], v[136:139]
    ds_read_b128 a[84:87], v29 offset:34816
    s_xor_b32 s33, s32, 128
    v_mfma_f32_16x16x32_bf16 v[144:147], a[0:3], a[72:75], v[144:147]
    buffer_load_dwordx4 v8, s[56:59], s33 offen offset:0  lds
    v_mfma_f32_16x16x32_bf16 v[152:155], a[0:3], a[76:79], v[152:155]
    ds_read_b128 a[88:91], v29 offset:36864
    v_mfma_f32_16x16x32_bf16 v[156:159], a[4:7], a[76:79], v[156:159]
    ds_read_b128 a[92:95], v29 offset:38912
    v_mfma_f32_16x16x32_bf16 v[148:151], a[4:7], a[72:75], v[148:151]
    ds_read_b64_tr_b16 a[32:33], v48 offset:16384
    v_mfma_f32_16x16x32_bf16 v[140:143], a[4:7], a[68:71], v[140:143]
    buffer_load_dwordx4 v9, s[56:59], s33 offen offset:1024  lds
    v_mfma_f32_16x16x32_bf16 v[132:135], a[4:7], a[64:67], v[132:135]
    ds_read_b64_tr_b16 a[34:35], v48 offset:20480
    v_mfma_f32_16x16x32_bf16 v[160:163], a[8:11], a[64:67], v[160:163]
    ds_read_b64_tr_b16 a[36:37], v49 offset:16384
    v_mfma_f32_16x16x32_bf16 v[168:171], a[8:11], a[68:71], v[168:171]
    ds_read_b64_tr_b16 a[38:39], v49 offset:20480
    v_mfma_f32_16x16x32_bf16 v[176:179], a[8:11], a[72:75], v[176:179]
    buffer_load_dwordx4 v10, s[56:59], s33 offen offset:2048  lds
    v_mfma_f32_16x16x32_bf16 v[184:187], a[8:11], a[76:79], v[184:187]
    ds_read_b64_tr_b16 a[40:41], v50 offset:16384
    v_mfma_f32_16x16x32_bf16 v[188:191], a[12:15], a[76:79], v[188:191]
    ds_read_b64_tr_b16 a[42:43], v50 offset:20480
    v_mfma_f32_16x16x32_bf16 v[180:183], a[12:15], a[72:75], v[180:183]
    ds_read_b64_tr_b16 a[44:45], v51 offset:16384
    v_mfma_f32_16x16x32_bf16 v[172:175], a[12:15], a[68:71], v[172:175]
    buffer_load_dwordx4 v11, s[56:59], s33 offen offset:3072  lds
    v_mfma_f32_16x16x32_bf16 v[164:167], a[12:15], a[64:67], v[164:167]
    ds_read_b64_tr_b16 a[46:47], v51 offset:20480
    v_mfma_f32_16x16x32_bf16 v[192:195], a[16:19], a[64:67], v[192:195]
    ds_read_b64_tr_b16 a[48:49], v52 offset:16384
    v_mfma_f32_16x16x32_bf16 v[200:203], a[16:19], a[68:71], v[200:203]
    ds_read_b64_tr_b16 a[50:51], v52 offset:20480
    v_mfma_f32_16x16x32_bf16 v[208:211], a[16:19], a[72:75], v[208:211]
    ds_read_b64_tr_b16 a[52:53], v53 offset:16384
    v_mfma_f32_16x16x32_bf16 v[216:219], a[16:19], a[76:79], v[216:219]
    ds_read_b64_tr_b16 a[54:55], v53 offset:20480
    v_mfma_f32_16x16x32_bf16 v[220:223], a[20:23], a[76:79], v[220:223]
    ds_read_b64_tr_b16 a[56:57], v54 offset:16384
    v_mfma_f32_16x16x32_bf16 v[212:215], a[20:23], a[72:75], v[212:215]
    ds_read_b64_tr_b16 a[58:59], v54 offset:20480
    v_mfma_f32_16x16x32_bf16 v[204:207], a[20:23], a[68:71], v[204:207]
    ds_read_b64_tr_b16 a[60:61], v55 offset:16384
    v_mfma_f32_16x16x32_bf16 v[196:199], a[20:23], a[64:67], v[196:199]
    ds_read_b64_tr_b16 a[62:63], v55 offset:20480
    v_mfma_f32_16x16x32_bf16 v[224:227], a[24:27], a[64:67], v[224:227]
    v_mfma_f32_16x16x32_bf16 v[232:235], a[24:27], a[68:71], v[232:235]
    v_mfma_f32_16x16x32_bf16 v[240:243], a[24:27], a[72:75], v[240:243]
    v_mfma_f32_16x16x32_bf16 v[248:251], a[24:27], a[76:79], v[248:251]
    v_mfma_f32_16x16x32_bf16 v[252:255], a[28:31], a[76:79], v[252:255]
    v_mfma_f32_16x16x32_bf16 v[244:247], a[28:31], a[72:75], v[244:247]
    v_mfma_f32_16x16x32_bf16 v[236:239], a[28:31], a[68:71], v[236:239]
    v_mfma_f32_16x16x32_bf16 v[228:231], a[28:31], a[64:67], v[228:231]
    s_waitcnt vmcnt(8) lgkmcnt(0)
    s_barrier
    v_mfma_f32_16x16x32_bf16 v[128:131], a[32:35], a[80:83], v[128:131]
    ds_read_b128 a[64:67], v28 offset:49152
    v_mfma_f32_16x16x32_bf16 v[136:139], a[32:35], a[84:87], v[136:139]
    ds_read_b128 a[68:71], v28 offset:51200
    v_mfma_f32_16x16x32_bf16 v[144:147], a[32:35], a[88:91], v[144:147]
    ds_read_b128 a[72:75], v28 offset:53248
    v_mfma_f32_16x16x32_bf16 v[152:155], a[32:35], a[92:95], v[152:155]
    ds_read_b128 a[76:79], v28 offset:55296
    v_mfma_f32_16x16x32_bf16 v[156:159], a[36:39], a[92:95], v[156:159]
    ds_read_b64_tr_b16 a[0:1], v48 offset:32768
    v_mfma_f32_16x16x32_bf16 v[148:151], a[36:39], a[88:91], v[148:151]
    ds_read_b64_tr_b16 a[2:3], v48 offset:36864
    v_mfma_f32_16x16x32_bf16 v[140:143], a[36:39], a[84:87], v[140:143]
    ds_read_b64_tr_b16 a[4:5], v49 offset:32768
    v_mfma_f32_16x16x32_bf16 v[132:135], a[36:39], a[80:83], v[132:135]
    ds_read_b64_tr_b16 a[6:7], v49 offset:36864
    v_mfma_f32_16x16x32_bf16 v[160:163], a[40:43], a[80:83], v[160:163]
    ds_read_b64_tr_b16 a[8:9], v50 offset:32768
    v_mfma_f32_16x16x32_bf16 v[168:171], a[40:43], a[84:87], v[168:171]
    ds_read_b64_tr_b16 a[10:11], v50 offset:36864
    v_mfma_f32_16x16x32_bf16 v[176:179], a[40:43], a[88:91], v[176:179]
    ds_read_b64_tr_b16 a[12:13], v51 offset:32768
    v_mfma_f32_16x16x32_bf16 v[184:187], a[40:43], a[92:95], v[184:187]
    ds_read_b64_tr_b16 a[14:15], v51 offset:36864
    v_mfma_f32_16x16x32_bf16 v[188:191], a[44:47], a[92:95], v[188:191]
    ds_read_b64_tr_b16 a[16:17], v52 offset:32768
    v_mfma_f32_16x16x32_bf16 v[180:183], a[44:47], a[88:91], v[180:183]
    ds_read_b64_tr_b16 a[18:19], v52 offset:36864
    s_add_u32 m0, s38, 65536
    v_mfma_f32_16x16x32_bf16 v[172:175], a[44:47], a[84:87], v[172:175]
    ds_read_b64_tr_b16 a[20:21], v53 offset:32768
    s_xor_b32 s33, s26, 0
    v_mfma_f32_16x16x32_bf16 v[164:167], a[44:47], a[80:83], v[164:167]
    ds_read_b64_tr_b16 a[22:23], v53 offset:36864
    v_mfma_f32_16x16x32_bf16 v[192:195], a[48:51], a[80:83], v[192:195]
    buffer_load_dwordx4 v12, s[48:51], s33 offen offset:0  lds
    v_mfma_f32_16x16x32_bf16 v[200:203], a[48:51], a[84:87], v[200:203]
    ds_read_b64_tr_b16 a[24:25], v54 offset:32768
    v_mfma_f32_16x16x32_bf16 v[208:211], a[48:51], a[88:91], v[208:211]
    ds_read_b64_tr_b16 a[26:27], v54 offset:36864
    v_mfma_f32_16x16x32_bf16 v[216:219], a[48:51], a[92:95], v[216:219]
    ds_read_b64_tr_b16 a[28:29], v55 offset:32768
    v_mfma_f32_16x16x32_bf16 v[220:223], a[52:55], a[92:95], v[220:223]
    buffer_load_dwordx4 v13, s[48:51], s33 offen offset:1024  lds
    v_mfma_f32_16x16x32_bf16 v[212:215], a[52:55], a[88:91], v[212:215]
    ds_read_b64_tr_b16 a[30:31], v55 offset:36864
    v_mfma_f32_16x16x32_bf16 v[204:207], a[52:55], a[84:87], v[204:207]
    v_mfma_f32_16x16x32_bf16 v[196:199], a[52:55], a[80:83], v[196:199]
    v_mfma_f32_16x16x32_bf16 v[224:227], a[56:59], a[80:83], v[224:227]
    buffer_load_dwordx4 v12, s[48:51], s33 offen offset:2048  lds
    v_mfma_f32_16x16x32_bf16 v[232:235], a[56:59], a[84:87], v[232:235]
    v_mfma_f32_16x16x32_bf16 v[240:243], a[56:59], a[88:91], v[240:243]
    v_mfma_f32_16x16x32_bf16 v[248:251], a[56:59], a[92:95], v[248:251]
    v_mfma_f32_16x16x32_bf16 v[252:255], a[60:63], a[92:95], v[252:255]
    buffer_load_dwordx4 v13, s[48:51], s33 offen offset:3072  lds
    v_mfma_f32_16x16x32_bf16 v[244:247], a[60:63], a[88:91], v[244:247]
    v_mfma_f32_16x16x32_bf16 v[236:239], a[60:63], a[84:87], v[236:239]
    v_mfma_f32_16x16x32_bf16 v[228:231], a[60:63], a[80:83], v[228:231]
    s_waitcnt vmcnt(8) lgkmcnt(0)
    s_barrier
    v_mfma_f32_16x16x32_bf16 v[128:131], a[0:3], a[64:67], v[128:131]
    ds_read_b128 a[80:83], v29 offset:49152
    s_add_u32 m0, s38, 69632
    v_mfma_f32_16x16x32_bf16 v[136:139], a[0:3], a[68:71], v[136:139]
    ds_read_b128 a[84:87], v29 offset:51200
    s_xor_b32 s33, s26, 4096
    v_mfma_f32_16x16x32_bf16 v[144:147], a[0:3], a[72:75], v[144:147]
    buffer_load_dwordx4 v12, s[48:51], s33 offen offset:0  lds
    v_mfma_f32_16x16x32_bf16 v[152:155], a[0:3], a[76:79], v[152:155]
    ds_read_b128 a[88:91], v29 offset:53248
    v_mfma_f32_16x16x32_bf16 v[156:159], a[4:7], a[76:79], v[156:159]
    ds_read_b128 a[92:95], v29 offset:55296
    v_mfma_f32_16x16x32_bf16 v[148:151], a[4:7], a[72:75], v[148:151]
    ds_read_b64_tr_b16 a[32:33], v48 offset:49152
    v_mfma_f32_16x16x32_bf16 v[140:143], a[4:7], a[68:71], v[140:143]
    buffer_load_dwordx4 v13, s[48:51], s33 offen offset:1024  lds
    v_mfma_f32_16x16x32_bf16 v[132:135], a[4:7], a[64:67], v[132:135]
    ds_read_b64_tr_b16 a[34:35], v48 offset:53248
    v_mfma_f32_16x16x32_bf16 v[160:163], a[8:11], a[64:67], v[160:163]
    ds_read_b64_tr_b16 a[36:37], v49 offset:49152
    v_mfma_f32_16x16x32_bf16 v[168:171], a[8:11], a[68:71], v[168:171]
    ds_read_b64_tr_b16 a[38:39], v49 offset:53248
    v_mfma_f32_16x16x32_bf16 v[176:179], a[8:11], a[72:75], v[176:179]
    buffer_load_dwordx4 v12, s[48:51], s33 offen offset:2048  lds
    v_mfma_f32_16x16x32_bf16 v[184:187], a[8:11], a[76:79], v[184:187]
    ds_read_b64_tr_b16 a[40:41], v50 offset:49152
    v_mfma_f32_16x16x32_bf16 v[188:191], a[12:15], a[76:79], v[188:191]
    ds_read_b64_tr_b16 a[42:43], v50 offset:53248
    v_mfma_f32_16x16x32_bf16 v[180:183], a[12:15], a[72:75], v[180:183]
    ds_read_b64_tr_b16 a[44:45], v51 offset:49152
    v_mfma_f32_16x16x32_bf16 v[172:175], a[12:15], a[68:71], v[172:175]
    buffer_load_dwordx4 v13, s[48:51], s33 offen offset:3072  lds
    v_mfma_f32_16x16x32_bf16 v[164:167], a[12:15], a[64:67], v[164:167]
    ds_read_b64_tr_b16 a[46:47], v51 offset:53248
    v_mfma_f32_16x16x32_bf16 v[192:195], a[16:19], a[64:67], v[192:195]
    ds_read_b64_tr_b16 a[48:49], v52 offset:49152
    v_mfma_f32_16x16x32_bf16 v[200:203], a[16:19], a[68:71], v[200:203]
    ds_read_b64_tr_b16 a[50:51], v52 offset:53248
    v_mfma_f32_16x16x32_bf16 v[208:211], a[16:19], a[72:75], v[208:211]
    ds_read_b64_tr_b16 a[52:53], v53 offset:49152
    v_mfma_f32_16x16x32_bf16 v[216:219], a[16:19], a[76:79], v[216:219]
    ds_read_b64_tr_b16 a[54:55], v53 offset:53248
    v_mfma_f32_16x16x32_bf16 v[220:223], a[20:23], a[76:79], v[220:223]
    ds_read_b64_tr_b16 a[56:57], v54 offset:49152
    v_mfma_f32_16x16x32_bf16 v[212:215], a[20:23], a[72:75], v[212:215]
    ds_read_b64_tr_b16 a[58:59], v54 offset:53248
    v_mfma_f32_16x16x32_bf16 v[204:207], a[20:23], a[68:71], v[204:207]
    ds_read_b64_tr_b16 a[60:61], v55 offset:49152
    v_mfma_f32_16x16x32_bf16 v[196:199], a[20:23], a[64:67], v[196:199]
    ds_read_b64_tr_b16 a[62:63], v55 offset:53248
    v_mfma_f32_16x16x32_bf16 v[224:227], a[24:27], a[64:67], v[224:227]
    v_mfma_f32_16x16x32_bf16 v[232:235], a[24:27], a[68:71], v[232:235]
    v_mfma_f32_16x16x32_bf16 v[240:243], a[24:27], a[72:75], v[240:243]
    v_mfma_f32_16x16x32_bf16 v[248:251], a[24:27], a[76:79], v[248:251]
    v_mfma_f32_16x16x32_bf16 v[252:255], a[28:31], a[76:79], v[252:255]
    v_mfma_f32_16x16x32_bf16 v[244:247], a[28:31], a[72:75], v[244:247]
    v_mfma_f32_16x16x32_bf16 v[236:239], a[28:31], a[68:71], v[236:239]
    v_mfma_f32_16x16x32_bf16 v[228:231], a[28:31], a[64:67], v[228:231]
    s_waitcnt vmcnt(63) lgkmcnt(0)
    s_barrier
    v_mfma_f32_16x16x32_bf16 v[128:131], a[32:35], a[80:83], v[128:131]
    v_mfma_f32_16x16x32_bf16 v[136:139], a[32:35], a[84:87], v[136:139]
    v_mfma_f32_16x16x32_bf16 v[140:143], a[36:39], a[84:87], v[140:143]
    v_add_u32 v4, 98304, v0
    v_mfma_f32_16x16x32_bf16 v[132:135], a[36:39], a[80:83], v[132:135]
    v_mfma_f32_16x16x32_bf16 v[160:163], a[40:43], a[80:83], v[160:163]
    v_add_u32 v5, 98304, v1
    v_mfma_f32_16x16x32_bf16 v[168:171], a[40:43], a[84:87], v[168:171]
    v_mfma_f32_16x16x32_bf16 v[172:175], a[44:47], a[84:87], v[172:175]
    v_add_u32 v6, 98304, v2
    v_mfma_f32_16x16x32_bf16 v[164:167], a[44:47], a[80:83], v[164:167]
    v_mfma_f32_16x16x32_bf16 v[192:195], a[48:51], a[80:83], v[192:195]
    v_add_u32 v7, 98304, v3
    v_mfma_f32_16x16x32_bf16 v[200:203], a[48:51], a[84:87], v[200:203]
    v_mfma_f32_16x16x32_bf16 v[204:207], a[52:55], a[84:87], v[204:207]
    v_mfma_f32_16x16x32_bf16 v[196:199], a[52:55], a[80:83], v[196:199]
    v_mfma_f32_16x16x32_bf16 v[224:227], a[56:59], a[80:83], v[224:227]
    v_mfma_f32_16x16x32_bf16 v[232:235], a[56:59], a[84:87], v[232:235]
    v_mfma_f32_16x16x32_bf16 v[236:239], a[60:63], a[84:87], v[236:239]
    v_mfma_f32_16x16x32_bf16 v[228:231], a[60:63], a[80:83], v[228:231]
    v_mfma_f32_16x16x32_bf16 v[144:147], a[32:35], a[88:91], v[144:147]
    v_mfma_f32_16x16x32_bf16 v[152:155], a[32:35], a[92:95], v[152:155]
    v_mfma_f32_16x16x32_bf16 v[156:159], a[36:39], a[92:95], v[156:159]
    v_mfma_f32_16x16x32_bf16 v[148:151], a[36:39], a[88:91], v[148:151]
    v_mfma_f32_16x16x32_bf16 v[176:179], a[40:43], a[88:91], v[176:179]
    v_cvt_pk_bf16_f32 v64, v128, v129
    v_cvt_pk_bf16_f32 v65, v130, v131
    v_mfma_f32_16x16x32_bf16 v[184:187], a[40:43], a[92:95], v[184:187]
    v_cvt_pk_bf16_f32 v66, v132, v133
    v_cvt_pk_bf16_f32 v67, v134, v135
    v_mfma_f32_16x16x32_bf16 v[188:191], a[44:47], a[92:95], v[188:191]
    v_cvt_pk_bf16_f32 v80, v136, v137
    v_cvt_pk_bf16_f32 v81, v138, v139
    v_mfma_f32_16x16x32_bf16 v[180:183], a[44:47], a[88:91], v[180:183]
    v_cvt_pk_bf16_f32 v82, v140, v141
    v_cvt_pk_bf16_f32 v83, v142, v143
    v_mfma_f32_16x16x32_bf16 v[208:211], a[48:51], a[88:91], v[208:211]
    v_cvt_pk_bf16_f32 v68, v160, v161
    v_cvt_pk_bf16_f32 v69, v162, v163
    v_mfma_f32_16x16x32_bf16 v[216:219], a[48:51], a[92:95], v[216:219]
    v_cvt_pk_bf16_f32 v70, v164, v165
    v_cvt_pk_bf16_f32 v71, v166, v167
    v_mfma_f32_16x16x32_bf16 v[220:223], a[52:55], a[92:95], v[220:223]
    v_cvt_pk_bf16_f32 v84, v168, v169
    v_cvt_pk_bf16_f32 v85, v170, v171
    v_mfma_f32_16x16x32_bf16 v[212:215], a[52:55], a[88:91], v[212:215]
    v_cvt_pk_bf16_f32 v86, v172, v173
    v_cvt_pk_bf16_f32 v87, v174, v175
    v_mfma_f32_16x16x32_bf16 v[240:243], a[56:59], a[88:91], v[240:243]
    v_cvt_pk_bf16_f32 v72, v192, v193
    v_cvt_pk_bf16_f32 v73, v194, v195
    v_mfma_f32_16x16x32_bf16 v[248:251], a[56:59], a[92:95], v[248:251]
    v_cvt_pk_bf16_f32 v74, v196, v197
    v_cvt_pk_bf16_f32 v75, v198, v199
    v_mfma_f32_16x16x32_bf16 v[252:255], a[60:63], a[92:95], v[252:255]
    v_cvt_pk_bf16_f32 v88, v200, v201
    v_cvt_pk_bf16_f32 v89, v202, v203
    v_mfma_f32_16x16x32_bf16 v[244:247], a[60:63], a[88:91], v[244:247]
    v_cvt_pk_bf16_f32 v90, v204, v205
    v_cvt_pk_bf16_f32 v91, v206, v207
    s_waitcnt lgkmcnt(0)
    s_load_dword s14, s[6:7], s13
    v_mfma_f32_16x16x32_bf16 v[128:131], a[128:131], v[64:67], 0
    v_cvt_pk_bf16_f32 v76, v224, v225
    v_cvt_pk_bf16_f32 v77, v226, v227
    v_mfma_f32_16x16x32_bf16 v[132:135], a[144:147], v[64:67], 0
    s_add_u32 m0, s37, 16384
    s_xor_b32 s33, s32, 256
    v_mfma_f32_16x16x32_bf16 v[136:139], a[128:131], v[80:83], 0
    buffer_load_dwordx4 v8, s[56:59], s33 offen offset:0  lds
    v_cvt_pk_bf16_f32 v78, v228, v229
    v_mfma_f32_16x16x32_bf16 v[140:143], a[144:147], v[80:83], 0
    v_cvt_pk_bf16_f32 v79, v230, v231
    v_cvt_pk_bf16_f32 v92, v232, v233
    v_mfma_f32_16x16x32_bf16 v[128:131], a[132:135], v[68:71], v[128:131]
    buffer_load_dwordx4 v9, s[56:59], s33 offen offset:1024  lds
    v_cvt_pk_bf16_f32 v93, v234, v235
    v_mfma_f32_16x16x32_bf16 v[132:135], a[148:151], v[68:71], v[132:135]
    v_cvt_pk_bf16_f32 v94, v236, v237
    v_cvt_pk_bf16_f32 v95, v238, v239
    v_mfma_f32_16x16x32_bf16 v[136:139], a[132:135], v[84:87], v[136:139]
    buffer_load_dwordx4 v10, s[56:59], s33 offen offset:2048  lds
    v_cvt_pk_bf16_f32 v96, v144, v145
    v_mfma_f32_16x16x32_bf16 v[140:143], a[148:151], v[84:87], v[140:143]
    v_cvt_pk_bf16_f32 v97, v146, v147
    v_cvt_pk_bf16_f32 v98, v148, v149
    v_mfma_f32_16x16x32_bf16 v[128:131], a[136:139], v[72:75], v[128:131]
    buffer_load_dwordx4 v11, s[56:59], s33 offen offset:3072  lds
    v_cvt_pk_bf16_f32 v99, v150, v151
    v_mfma_f32_16x16x32_bf16 v[132:135], a[152:155], v[72:75], v[132:135]
    v_cvt_pk_bf16_f32 v112, v152, v153
    v_cvt_pk_bf16_f32 v113, v154, v155
    v_mfma_f32_16x16x32_bf16 v[136:139], a[136:139], v[88:91], v[136:139]
    v_cvt_pk_bf16_f32 v114, v156, v157
    v_cvt_pk_bf16_f32 v115, v158, v159
    v_mfma_f32_16x16x32_bf16 v[140:143], a[152:155], v[88:91], v[140:143]
    v_cvt_pk_bf16_f32 v100, v176, v177
    v_cvt_pk_bf16_f32 v101, v178, v179
    v_mfma_f32_16x16x32_bf16 v[128:131], a[140:143], v[76:79], v[128:131]
    v_cvt_pk_bf16_f32 v102, v180, v181
    v_cvt_pk_bf16_f32 v103, v182, v183
    v_mfma_f32_16x16x32_bf16 v[132:135], a[156:159], v[76:79], v[132:135]
    v_cvt_pk_bf16_f32 v116, v184, v185
    v_cvt_pk_bf16_f32 v117, v186, v187
    v_mfma_f32_16x16x32_bf16 v[136:139], a[140:143], v[92:95], v[136:139]
    v_cvt_pk_bf16_f32 v118, v188, v189
    v_cvt_pk_bf16_f32 v119, v190, v191
    v_mfma_f32_16x16x32_bf16 v[140:143], a[156:159], v[92:95], v[140:143]
    v_cvt_pk_bf16_f32 v104, v208, v209
    v_cvt_pk_bf16_f32 v105, v210, v211
    v_cvt_pk_bf16_f32 v106, v212, v213
    v_cvt_pk_bf16_f32 v107, v214, v215
    v_cvt_pk_bf16_f32 v120, v216, v217
    v_cvt_pk_bf16_f32 v121, v218, v219
    v_cvt_pk_bf16_f32 v122, v220, v221
    v_cvt_pk_bf16_f32 v123, v222, v223
    v_mfma_f32_16x16x32_bf16 v[160:163], a[160:163], v[96:99], 0
    v_cvt_pk_bf16_f32 v108, v240, v241
    v_cvt_pk_bf16_f32 v109, v242, v243
    v_mfma_f32_16x16x32_bf16 v[164:167], a[176:179], v[96:99], 0
    s_add_u32 m0, s37, 32768
    s_xor_b32 s33, s32, 384
    v_mfma_f32_16x16x32_bf16 v[168:171], a[160:163], v[112:115], 0
    buffer_load_dwordx4 v8, s[56:59], s33 offen offset:0  lds
    v_cvt_pk_bf16_f32 v110, v244, v245
    v_cvt_pk_bf16_f32 v111, v246, v247
    v_mfma_f32_16x16x32_bf16 v[172:175], a[176:179], v[112:115], 0
    v_cvt_pk_bf16_f32 v124, v248, v249
    v_cvt_pk_bf16_f32 v125, v250, v251
    v_mfma_f32_16x16x32_bf16 v[160:163], a[164:167], v[100:103], v[160:163]
    buffer_load_dwordx4 v9, s[56:59], s33 offen offset:1024  lds
    v_cvt_pk_bf16_f32 v126, v252, v253
    v_cvt_pk_bf16_f32 v127, v254, v255
    v_mfma_f32_16x16x32_bf16 v[164:167], a[180:183], v[100:103], v[164:167]
    v_max3_f32 v40, v128, v129, v130
    v_max3_f32 v41, v136, v137, v138
    v_mfma_f32_16x16x32_bf16 v[168:171], a[164:167], v[116:119], v[168:171]
    buffer_load_dwordx4 v10, s[56:59], s33 offen offset:2048  lds
    v_max3_f32 v40, v40, v131, v132
    v_max3_f32 v41, v41, v139, v140
    v_mfma_f32_16x16x32_bf16 v[172:175], a[180:183], v[116:119], v[172:175]
    v_max3_f32 v40, v40, v133, v134
    v_max3_f32 v41, v41, v141, v142
    v_mfma_f32_16x16x32_bf16 v[160:163], a[168:171], v[104:107], v[160:163]
    buffer_load_dwordx4 v11, s[56:59], s33 offen offset:3072  lds
    v_max_f32 v40, v40, v135
    v_mfma_f32_16x16x32_bf16 v[164:167], a[184:187], v[104:107], v[164:167]
    v_max_f32 v41, v41, v143
    s_nop 0
    v_mfma_f32_16x16x32_bf16 v[168:171], a[168:171], v[120:123], v[168:171]
    v_permlane32_swap_b32 v40, v41
    v_mfma_f32_16x16x32_bf16 v[172:175], a[184:187], v[120:123], v[172:175]
    v_max_f32 v40, v40, v41
    v_mov_b32 v41, v40
    v_mfma_f32_16x16x32_bf16 v[160:163], a[172:175], v[108:111], v[160:163]
    s_nop 0
    v_mfma_f32_16x16x32_bf16 v[164:167], a[188:191], v[108:111], v[164:167]
    v_permlane16_swap_b32 v40, v41
    v_max_f32 v40, v40, v41
    v_mfma_f32_16x16x32_bf16 v[168:171], a[172:175], v[124:127], v[168:171]
    v_mul_f32 v40, s35, v40
    v_mov_b32 v41, v40
    v_mfma_f32_16x16x32_bf16 v[172:175], a[188:191], v[124:127], v[172:175]
    s_nop 0
    v_permlane32_swap_b32 v40, v41
    s_xor_b32 s39, s16, 131072
    v_pk_fma_f32 v[128:129], v[128:129], s[34:35], v[40:41] op_sel:[0,0,0] op_sel_hi:[1,0,0]
    v_pk_fma_f32 v[130:131], v[130:131], s[34:35], v[40:41] op_sel:[0,0,0] op_sel_hi:[1,0,0]
    v_pk_fma_f32 v[132:133], v[132:133], s[34:35], v[40:41] op_sel:[0,0,0] op_sel_hi:[1,0,0]
    v_pk_fma_f32 v[134:135], v[134:135], s[34:35], v[40:41] op_sel:[0,0,0] op_sel_hi:[1,0,0]
    v_pk_fma_f32 v[136:137], v[136:137], s[34:35], v[40:41] op_sel:[0,0,1] op_sel_hi:[1,0,1]
    v_pk_fma_f32 v[138:139], v[138:139], s[34:35], v[40:41] op_sel:[0,0,1] op_sel_hi:[1,0,1]
    v_pk_fma_f32 v[140:141], v[140:141], s[34:35], v[40:41] op_sel:[0,0,1] op_sel_hi:[1,0,1]
    v_pk_fma_f32 v[142:143], v[142:143], s[34:35], v[40:41] op_sel:[0,0,1] op_sel_hi:[1,0,1]
    v_max3_f32 v42, v160, v161, v162
    v_max3_f32 v43, v168, v169, v170
    v_max3_f32 v42, v42, v163, v164
    v_max3_f32 v43, v43, v171, v172
    v_max3_f32 v42, v42, v165, v166
    v_max3_f32 v43, v43, v173, v174
    v_max_f32 v42, v42, v167
    v_max_f32 v43, v43, v175
    v_exp_f32 v128, v128
    v_exp_f32 v129, v129
    v_permlane32_swap_b32 v42, v43
    v_max_f32 v42, v42, v43
    v_mov_b32 v43, v42
    v_exp_f32 v130, v130
    v_exp_f32 v131, v131
    v_permlane16_swap_b32 v42, v43
    v_max_f32 v42, v42, v43
    v_mul_f32 v42, s35, v42
    v_mov_b32 v43, v42
    v_exp_f32 v132, v132
    v_exp_f32 v133, v133
    v_permlane32_swap_b32 v42, v43
    v_exp_f32 v134, v134
    v_exp_f32 v135, v135
    v_exp_f32 v136, v136
    v_exp_f32 v137, v137
    v_exp_f32 v138, v138
    v_exp_f32 v139, v139
    v_exp_f32 v140, v140
    v_exp_f32 v141, v141
    v_exp_f32 v142, v142
    v_exp_f32 v143, v143
    v_pk_fma_f32 v[160:161], v[160:161], s[34:35], v[42:43] op_sel:[0,0,0] op_sel_hi:[1,0,0]
    v_pk_fma_f32 v[162:163], v[162:163], s[34:35], v[42:43] op_sel:[0,0,0] op_sel_hi:[1,0,0]
    v_pk_fma_f32 v[164:165], v[164:165], s[34:35], v[42:43] op_sel:[0,0,0] op_sel_hi:[1,0,0]
    v_pk_fma_f32 v[166:167], v[166:167], s[34:35], v[42:43] op_sel:[0,0,0] op_sel_hi:[1,0,0]
    v_pk_fma_f32 v[168:169], v[168:169], s[34:35], v[42:43] op_sel:[0,0,1] op_sel_hi:[1,0,1]
    v_pk_fma_f32 v[170:171], v[170:171], s[34:35], v[42:43] op_sel:[0,0,1] op_sel_hi:[1,0,1]
    v_pk_fma_f32 v[172:173], v[172:173], s[34:35], v[42:43] op_sel:[0,0,1] op_sel_hi:[1,0,1]
    v_pk_fma_f32 v[174:175], v[174:175], s[34:35], v[42:43] op_sel:[0,0,1] op_sel_hi:[1,0,1]
    v_pk_add_f32 v[48:49], v[128:129], v[130:131]
    v_pk_add_f32 v[52:53], v[136:137], v[138:139]
    v_pk_add_f32 v[50:51], v[132:133], v[134:135]
    v_pk_add_f32 v[54:55], v[140:141], v[142:143]
    v_pk_add_f32 v[48:49], v[48:49], v[50:51]
    v_pk_add_f32 v[52:53], v[52:53], v[54:55]
    v_add_f32 v40, v48, v49
    v_add_f32 v41, v52, v53
    v_exp_f32 v160, v160
    v_exp_f32 v161, v161
    v_permlane32_swap_b32 v40, v41
    v_add_f32 v40, v40, v41
    v_mov_b32 v41, v40
    v_exp_f32 v162, v162
    v_exp_f32 v163, v163
    v_permlane16_swap_b32 v40, v41
    v_add_f32 v40, v40, v41
    v_rcp_f32 v40, v40
    v_exp_f32 v164, v164
    v_mov_b32 v41, v40
    v_exp_f32 v165, v165
    v_exp_f32 v166, v166
    v_permlane32_swap_b32 v40, v41
    v_exp_f32 v167, v167
    v_exp_f32 v168, v168
    v_exp_f32 v169, v169
    v_exp_f32 v170, v170
    v_exp_f32 v171, v171
    v_exp_f32 v172, v172
    v_exp_f32 v173, v173
    v_exp_f32 v174, v174
    v_exp_f32 v175, v175
    v_pk_add_f32 v[56:57], v[160:161], v[162:163]
    v_pk_add_f32 v[60:61], v[168:169], v[170:171]
    v_pk_add_f32 v[58:59], v[164:165], v[166:167]
    v_pk_add_f32 v[62:63], v[172:173], v[174:175]
    v_pk_add_f32 v[56:57], v[56:57], v[58:59]
    v_pk_add_f32 v[60:61], v[60:61], v[62:63]
    v_add_f32 v42, v56, v57
    v_add_f32 v43, v60, v61
    v_pk_mul_f32 v[128:129], v[128:129], v[40:41] op_sel:[0,0] op_sel_hi:[1,0]
    v_pk_mul_f32 v[130:131], v[130:131], v[40:41] op_sel:[0,0] op_sel_hi:[1,0]
    v_permlane32_swap_b32 v42, v43
    v_add_f32 v42, v42, v43
    s_add_u32 m0, s37, 49152
    s_xor_b32 s33, s32, 131200
    v_mov_b32 v43, v42
    v_pk_mul_f32 v[132:133], v[132:133], v[40:41] op_sel:[0,0] op_sel_hi:[1,0]
    v_pk_mul_f32 v[134:135], v[134:135], v[40:41] op_sel:[0,0] op_sel_hi:[1,0]
    v_permlane16_swap_b32 v42, v43
    v_add_f32 v42, v42, v43
    v_rcp_f32 v42, v42
    v_cvt_pk_bf16_f32 v48, v128, v129
    v_mov_b32 v43, v42
    v_cvt_pk_bf16_f32 v49, v130, v131
    v_cvt_pk_bf16_f32 v50, v132, v133
    v_permlane32_swap_b32 v42, v43
    buffer_load_dwordx4 v8, s[56:59], s33 offen offset:0  lds
    v_cvt_pk_bf16_f32 v51, v134, v135
    ds_write_b128 v30, v[48:51] offset:0
    buffer_store_dwordx4 v[48:51], v14, s[60:63], s39 offen offset:0 sc1
    v_pk_mul_f32 v[136:137], v[136:137], v[40:41] op_sel:[0,1] op_sel_hi:[1,1]
    v_pk_mul_f32 v[138:139], v[138:139], v[40:41] op_sel:[0,1] op_sel_hi:[1,1]
    v_pk_mul_f32 v[140:141], v[140:141], v[40:41] op_sel:[0,1] op_sel_hi:[1,1]
    v_pk_mul_f32 v[142:143], v[142:143], v[40:41] op_sel:[0,1] op_sel_hi:[1,1]
    v_cvt_pk_bf16_f32 v52, v136, v137
    v_cvt_pk_bf16_f32 v53, v138, v139
    v_cvt_pk_bf16_f32 v54, v140, v141
    v_cvt_pk_bf16_f32 v55, v142, v143
    buffer_load_dwordx4 v9, s[56:59], s33 offen offset:1024  lds
    ds_write_b128 v30, v[52:55] offset:1024
    buffer_store_dwordx4 v[52:55], v14, s[60:63], s39 offen offset:1024 sc1
    v_pk_mul_f32 v[160:161], v[160:161], v[42:43] op_sel:[0,0] op_sel_hi:[1,0]
    v_pk_mul_f32 v[162:163], v[162:163], v[42:43] op_sel:[0,0] op_sel_hi:[1,0]
    v_pk_mul_f32 v[164:165], v[164:165], v[42:43] op_sel:[0,0] op_sel_hi:[1,0]
    v_pk_mul_f32 v[166:167], v[166:167], v[42:43] op_sel:[0,0] op_sel_hi:[1,0]
    v_cvt_pk_bf16_f32 v56, v160, v161
    v_cvt_pk_bf16_f32 v57, v162, v163
    v_cvt_pk_bf16_f32 v58, v164, v165
    v_cvt_pk_bf16_f32 v59, v166, v167
    ds_write_b128 v30, v[56:59] offset:2048
    buffer_load_dwordx4 v10, s[56:59], s33 offen offset:2048  lds
    buffer_store_dwordx4 v[56:59], v14, s[60:63], s39 offen offset:2048 sc1
    v_pk_mul_f32 v[168:169], v[168:169], v[42:43] op_sel:[0,1] op_sel_hi:[1,1]
    v_pk_mul_f32 v[170:171], v[170:171], v[42:43] op_sel:[0,1] op_sel_hi:[1,1]
    v_pk_mul_f32 v[172:173], v[172:173], v[42:43] op_sel:[0,1] op_sel_hi:[1,1]
    v_pk_mul_f32 v[174:175], v[174:175], v[42:43] op_sel:[0,1] op_sel_hi:[1,1]
    v_cvt_pk_bf16_f32 v60, v168, v169
    v_cvt_pk_bf16_f32 v61, v170, v171
    v_cvt_pk_bf16_f32 v62, v172, v173
    v_cvt_pk_bf16_f32 v63, v174, v175
    ds_write_b128 v30, v[60:63] offset:3072
    buffer_store_dwordx4 v[60:63], v14, s[60:63], s39 offen offset:3072 sc1
    buffer_load_dwordx4 v11, s[56:59], s33 offen offset:3072  lds
    s_waitcnt vmcnt(16)
    ds_read_b64_tr_b16 a[192:193], v16 offset:0
    ds_read_b64_tr_b16 a[194:195], v16 offset:4096
    ds_read_b64_tr_b16 a[196:197], v17 offset:0
    ds_read_b64_tr_b16 a[198:199], v17 offset:4096
    ds_read_b64_tr_b16 a[200:201], v18 offset:0
    ds_read_b64_tr_b16 a[202:203], v18 offset:4096
    ds_read_b64_tr_b16 a[204:205], v19 offset:0
    ds_read_b64_tr_b16 a[206:207], v19 offset:4096
    ds_read_b64_tr_b16 a[208:209], v20 offset:0
    ds_read_b64_tr_b16 a[210:211], v20 offset:4096
    ds_read_b64_tr_b16 a[212:213], v21 offset:0
    ds_read_b64_tr_b16 a[214:215], v21 offset:4096
    ds_read_b64_tr_b16 a[216:217], v22 offset:0
    ds_read_b64_tr_b16 a[218:219], v22 offset:4096
    ds_read_b64_tr_b16 a[220:221], v23 offset:0
    ds_read_b64_tr_b16 a[222:223], v23 offset:4096
    s_branch L_att
L_var1:
    s_add_u32 m0, s36, 16384
    s_xor_b32 s33, s30, 262144
    buffer_load_dwordx4 v4, s[52:55], s33 offen offset:0  lds
    buffer_load_dwordx4 v5, s[52:55], s33 offen offset:1024  lds
    buffer_load_dwordx4 v6, s[52:55], s33 offen offset:2048  lds
    buffer_load_dwordx4 v7, s[52:55], s33 offen offset:3072  lds
    s_waitcnt vmcnt(6)
    s_barrier
    ds_read_b128 a[64:67], v28 offset:0
    ds_read_b128 a[68:71], v28 offset:2048
    ds_read_b128 a[72:75], v28 offset:4096
    ds_read_b128 a[76:79], v28 offset:6144
    ds_read_b64_tr_b16 a[0:1], v48 offset:0
    ds_read_b64_tr_b16 a[2:3], v48 offset:4096
    ds_read_b64_tr_b16 a[4:5], v49 offset:0
    ds_read_b64_tr_b16 a[6:7], v49 offset:4096
    ds_read_b64_tr_b16 a[8:9], v50 offset:0
    ds_read_b64_tr_b16 a[10:11], v50 offset:4096
    ds_read_b64_tr_b16 a[12:13], v51 offset:0
    ds_read_b64_tr_b16 a[14:15], v51 offset:4096
    ds_read_b64_tr_b16 a[16:17], v52 offset:0
    ds_read_b64_tr_b16 a[18:19], v52 offset:4096
    ds_read_b64_tr_b16 a[20:21], v53 offset:0
    ds_read_b64_tr_b16 a[22:23], v53 offset:4096
    ds_read_b64_tr_b16 a[24:25], v54 offset:0
    ds_read_b64_tr_b16 a[26:27], v54 offset:4096
    ds_read_b64_tr_b16 a[28:29], v55 offset:0
    ds_read_b64_tr_b16 a[30:31], v55 offset:4096
    s_add_u32 m0, s37, 114688
    s_xor_b32 s33, s29, 128
    buffer_load_dwordx4 v44, s[40:43], s33 offen offset:0  lds
    buffer_load_dwordx4 v45, s[40:43], s33 offen offset:1024  lds
    buffer_load_dwordx4 v46, s[40:43], s33 offen offset:2048  lds
    buffer_load_dwordx4 v47, s[40:43], s33 offen offset:3072  lds
    s_add_u32 m0, s36, 32768
    s_xor_b32 s33, s30, 524288
    buffer_load_dwordx4 v4, s[52:55], s33 offen offset:0  lds
    buffer_load_dwordx4 v5, s[52:55], s33 offen offset:1024  lds
    buffer_load_dwordx4 v6, s[52:55], s33 offen offset:2048  lds
    buffer_load_dwordx4 v7, s[52:55], s33 offen offset:3072  lds
    s_waitcnt vmcnt(8) lgkmcnt(0)
    s_barrier
    v_mfma_f32_16x16x32_bf16 v[128:131], a[0:3], a[64:67], 0
    ds_read_b128 a[80:83], v29 offset:0
    s_add_u32 m0, s36, 49152
    v_mfma_f32_16x16x32_bf16 v[136:139], a[0:3], a[68:71], 0
    ds_read_b128 a[84:87], v29 offset:2048
    s_xor_b32 s33, s30, 786432
    v_mfma_f32_16x16x32_bf16 v[144:147], a[0:3], a[72:75], 0
    buffer_load_dwordx4 v4, s[52:55], s33 offen offset:0  lds
    v_mfma_f32_16x16x32_bf16 v[152:155], a[0:3], a[76:79], 0
    ds_read_b128 a[88:91], v29 offset:4096
    v_mfma_f32_16x16x32_bf16 v[156:159], a[4:7], a[76:79], 0
    ds_read_b128 a[92:95], v29 offset:6144
    v_mfma_f32_16x16x32_bf16 v[148:151], a[4:7], a[72:75], 0
    ds_read_b64_tr_b16 a[32:33], v48 offset:16384
    v_mfma_f32_16x16x32_bf16 v[140:143], a[4:7], a[68:71], 0
    buffer_load_dwordx4 v5, s[52:55], s33 offen offset:1024  lds
    v_mfma_f32_16x16x32_bf16 v[132:135], a[4:7], a[64:67], 0
    ds_read_b64_tr_b16 a[34:35], v48 offset:20480
    v_mfma_f32_16x16x32_bf16 v[160:163], a[8:11], a[64:67], 0
    ds_read_b64_tr_b16 a[36:37], v49 offset:16384
    v_mfma_f32_16x16x32_bf16 v[168:171], a[8:11], a[68:71], 0
    ds_read_b64_tr_b16 a[38:39], v49 offset:20480
    v_mfma_f32_16x16x32_bf16 v[176:179], a[8:11], a[72:75], 0
    buffer_load_dwordx4 v6, s[52:55], s33 offen offset:2048  lds
    v_mfma_f32_16x16x32_bf16 v[184:187], a[8:11], a[76:79], 0
    ds_read_b64_tr_b16 a[40:41], v50 offset:16384
    v_mfma_f32_16x16x32_bf16 v[188:191], a[12:15], a[76:79], 0
    ds_read_b64_tr_b16 a[42:43], v50 offset:20480
    v_mfma_f32_16x16x32_bf16 v[180:183], a[12:15], a[72:75], 0
    ds_read_b64_tr_b16 a[44:45], v51 offset:16384
    v_mfma_f32_16x16x32_bf16 v[172:175], a[12:15], a[68:71], 0
    buffer_load_dwordx4 v7, s[52:55], s33 offen offset:3072  lds
    s_add_u32 m0, s37, 131072
    v_mfma_f32_16x16x32_bf16 v[164:167], a[12:15], a[64:67], 0
    ds_read_b64_tr_b16 a[46:47], v51 offset:20480
    s_xor_b32 s33, s29, 256
    v_mfma_f32_16x16x32_bf16 v[192:195], a[16:19], a[64:67], 0
    ds_read_b64_tr_b16 a[48:49], v52 offset:16384
    v_mfma_f32_16x16x32_bf16 v[200:203], a[16:19], a[68:71], 0
    ds_read_b64_tr_b16 a[50:51], v52 offset:20480
    v_mfma_f32_16x16x32_bf16 v[208:211], a[16:19], a[72:75], 0
    buffer_load_dwordx4 v44, s[40:43], s33 offen offset:0  lds
    v_mfma_f32_16x16x32_bf16 v[216:219], a[16:19], a[76:79], 0
    ds_read_b64_tr_b16 a[52:53], v53 offset:16384
    v_mfma_f32_16x16x32_bf16 v[220:223], a[20:23], a[76:79], 0
    ds_read_b64_tr_b16 a[54:55], v53 offset:20480
    v_mfma_f32_16x16x32_bf16 v[212:215], a[20:23], a[72:75], 0
    ds_read_b64_tr_b16 a[56:57], v54 offset:16384
    v_mfma_f32_16x16x32_bf16 v[204:207], a[20:23], a[68:71], 0
    buffer_load_dwordx4 v45, s[40:43], s33 offen offset:1024  lds
    v_mfma_f32_16x16x32_bf16 v[196:199], a[20:23], a[64:67], 0
    ds_read_b64_tr_b16 a[58:59], v54 offset:20480
    v_mfma_f32_16x16x32_bf16 v[224:227], a[24:27], a[64:67], 0
    ds_read_b64_tr_b16 a[60:61], v55 offset:16384
    v_mfma_f32_16x16x32_bf16 v[232:235], a[24:27], a[68:71], 0
    ds_read_b64_tr_b16 a[62:63], v55 offset:20480
    v_mfma_f32_16x16x32_bf16 v[240:243], a[24:27], a[72:75], 0
    buffer_load_dwordx4 v46, s[40:43], s33 offen offset:2048  lds
    v_mfma_f32_16x16x32_bf16 v[248:251], a[24:27], a[76:79], 0
    v_mfma_f32_16x16x32_bf16 v[252:255], a[28:31], a[76:79], 0
    v_mfma_f32_16x16x32_bf16 v[244:247], a[28:31], a[72:75], 0
    v_mfma_f32_16x16x32_bf16 v[236:239], a[28:31], a[68:71], 0
    buffer_load_dwordx4 v47, s[40:43], s33 offen offset:3072  lds
    v_mfma_f32_16x16x32_bf16 v[228:231], a[28:31], a[64:67], 0
    s_waitcnt vmcnt(8) lgkmcnt(0)
    s_barrier
    s_cmp_lg_u32 s15, 0
    s_cbranch_scc1 L_nohs1
    s_atomic_add s20, s[6:7], s13
L_nohs1:
    v_mfma_f32_16x16x32_bf16 v[128:131], a[32:35], a[80:83], v[128:131]
    ds_read_b128 a[64:67], v28 offset:16384
    s_add_u32 m0, s38, 65536
    v_mfma_f32_16x16x32_bf16 v[136:139], a[32:35], a[84:87], v[136:139]
    ds_read_b128 a[68:71], v28 offset:18432
    s_xor_b32 s33, s31, 0
    v_mfma_f32_16x16x32_bf16 v[144:147], a[32:35], a[88:91], v[144:147]
    buffer_load_dwordx4 v24, s[44:47], s33 offen offset:0 nt lds
    v_mfma_f32_16x16x32_bf16 v[152:155], a[32:35], a[92:95], v[152:155]
    ds_read_b128 a[72:75], v28 offset:20480
    v_mfma_f32_16x16x32_bf16 v[156:159], a[36:39], a[92:95], v[156:159]
    ds_read_b128 a[76:79], v28 offset:22528
    v_mfma_f32_16x16x32_bf16 v[148:151], a[36:39], a[88:91], v[148:151]
    ds_read_b64_tr_b16 a[0:1], v48 offset:32768
    v_mfma_f32_16x16x32_bf16 v[140:143], a[36:39], a[84:87], v[140:143]
    buffer_load_dwordx4 v25, s[44:47], s33 offen offset:1024 nt lds
    v_mfma_f32_16x16x32_bf16 v[132:135], a[36:39], a[80:83], v[132:135]
    ds_read_b64_tr_b16 a[2:3], v48 offset:36864
    v_mfma_f32_16x16x32_bf16 v[160:163], a[40:43], a[80:83], v[160:163]
    ds_read_b64_tr_b16 a[4:5], v49 offset:32768
    v_mfma_f32_16x16x32_bf16 v[168:171], a[40:43], a[84:87], v[168:171]
    ds_read_b64_tr_b16 a[6:7], v49 offset:36864
    v_mfma_f32_16x16x32_bf16 v[176:179], a[40:43], a[88:91], v[176:179]
    buffer_load_dwordx4 v26, s[44:47], s33 offen offset:2048 nt lds
    v_mfma_f32_16x16x32_bf16 v[184:187], a[40:43], a[92:95], v[184:187]
    ds_read_b64_tr_b16 a[8:9], v50 offset:32768
    v_mfma_f32_16x16x32_bf16 v[188:191], a[44:47], a[92:95], v[188:191]
    ds_read_b64_tr_b16 a[10:11], v50 offset:36864
    v_mfma_f32_16x16x32_bf16 v[180:183], a[44:47], a[88:91], v[180:183]
    ds_read_b64_tr_b16 a[12:13], v51 offset:32768
    v_mfma_f32_16x16x32_bf16 v[172:175], a[44:47], a[84:87], v[172:175]
    buffer_load_dwordx4 v27, s[44:47], s33 offen offset:3072 nt lds
    s_add_u32 m0, s38, 69632
    v_mfma_f32_16x16x32_bf16 v[164:167], a[44:47], a[80:83], v[164:167]
    ds_read_b64_tr_b16 a[14:15], v51 offset:36864
    s_xor_b32 s33, s31, 4096
    v_mfma_f32_16x16x32_bf16 v[192:195], a[48:51], a[80:83], v[192:195]
    ds_read_b64_tr_b16 a[16:17], v52 offset:32768
    v_mfma_f32_16x16x32_bf16 v[200:203], a[48:51], a[84:87], v[200:203]
    ds_read_b64_tr_b16 a[18:19], v52 offset:36864
    v_mfma_f32_16x16x32_bf16 v[208:211], a[48:51], a[88:91], v[208:211]
    buffer_load_dwordx4 v24, s[44:47], s33 offen offset:0 nt lds
    v_mfma_f32_16x16x32_bf16 v[216:219], a[48:51], a[92:95], v[216:219]
    ds_read_b64_tr_b16 a[20:21], v53 offset:32768
    v_mfma_f32_16x16x32_bf16 v[220:223], a[52:55], a[92:95], v[220:223]
    ds_read_b64_tr_b16 a[22:23], v53 offset:36864
    v_mfma_f32_16x16x32_bf16 v[212:215], a[52:55], a[88:91], v[212:215]
    ds_read_b64_tr_b16 a[24:25], v54 offset:32768
    v_mfma_f32_16x16x32_bf16 v[204:207], a[52:55], a[84:87], v[204:207]
    buffer_load_dwordx4 v25, s[44:47], s33 offen offset:1024 nt lds
    v_mfma_f32_16x16x32_bf16 v[196:199], a[52:55], a[80:83], v[196:199]
    ds_read_b64_tr_b16 a[26:27], v54 offset:36864
    v_mfma_f32_16x16x32_bf16 v[224:227], a[56:59], a[80:83], v[224:227]
    ds_read_b64_tr_b16 a[28:29], v55 offset:32768
    v_mfma_f32_16x16x32_bf16 v[232:235], a[56:59], a[84:87], v[232:235]
    ds_read_b64_tr_b16 a[30:31], v55 offset:36864
    v_mfma_f32_16x16x32_bf16 v[240:243], a[56:59], a[88:91], v[240:243]
    buffer_load_dwordx4 v26, s[44:47], s33 offen offset:2048 nt lds
    v_mfma_f32_16x16x32_bf16 v[248:251], a[56:59], a[92:95], v[248:251]
    v_mfma_f32_16x16x32_bf16 v[252:255], a[60:63], a[92:95], v[252:255]
    v_mfma_f32_16x16x32_bf16 v[244:247], a[60:63], a[88:91], v[244:247]
    v_mfma_f32_16x16x32_bf16 v[236:239], a[60:63], a[84:87], v[236:239]
    buffer_load_dwordx4 v27, s[44:47], s33 offen offset:3072 nt lds
    v_mfma_f32_16x16x32_bf16 v[228:231], a[60:63], a[80:83], v[228:231]
    ds_read_b32 v58, v14
    s_waitcnt vmcnt(12) lgkmcnt(1)
    s_barrier
    v_mfma_f32_16x16x32_bf16 v[128:131], a[0:3], a[64:67], v[128:131]
    ds_read_b128 a[80:83], v29 offset:16384
    v_mfma_f32_16x16x32_bf16 v[136:139], a[0:3], a[68:71], v[136:139]
    ds_read_b128 a[84:87], v29 offset:18432
    v_mfma_f32_16x16x32_bf16 v[144:147], a[0:3], a[72:75], v[144:147]
    ds_read_b128 a[88:91], v29 offset:20480
    v_mfma_f32_16x16x32_bf16 v[152:155], a[0:3], a[76:79], v[152:155]
    ds_read_b128 a[92:95], v29 offset:22528
    v_mfma_f32_16x16x32_bf16 v[156:159], a[4:7], a[76:79], v[156:159]
    ds_read_b64_tr_b16 a[32:33], v48 offset:49152
    v_mfma_f32_16x16x32_bf16 v[148:151], a[4:7], a[72:75], v[148:151]
    ds_read_b64_tr_b16 a[34:35], v48 offset:53248
    v_mfma_f32_16x16x32_bf16 v[140:143], a[4:7], a[68:71], v[140:143]
    ds_read_b64_tr_b16 a[36:37], v49 offset:49152
    v_mfma_f32_16x16x32_bf16 v[132:135], a[4:7], a[64:67], v[132:135]
    ds_read_b64_tr_b16 a[38:39], v49 offset:53248
    v_mfma_f32_16x16x32_bf16 v[160:163], a[8:11], a[64:67], v[160:163]
    ds_read_b64_tr_b16 a[40:41], v50 offset:49152
    v_mfma_f32_16x16x32_bf16 v[168:171], a[8:11], a[68:71], v[168:171]
    ds_read_b64_tr_b16 a[42:43], v50 offset:53248
    v_mfma_f32_16x16x32_bf16 v[176:179], a[8:11], a[72:75], v[176:179]
    ds_read_b64_tr_b16 a[44:45], v51 offset:49152
    v_mfma_f32_16x16x32_bf16 v[184:187], a[8:11], a[76:79], v[184:187]
    ds_read_b64_tr_b16 a[46:47], v51 offset:53248
    v_mfma_f32_16x16x32_bf16 v[188:191], a[12:15], a[76:79], v[188:191]
    ds_read_b64_tr_b16 a[48:49], v52 offset:49152
    v_mfma_f32_16x16x32_bf16 v[180:183], a[12:15], a[72:75], v[180:183]
    ds_read_b64_tr_b16 a[50:51], v52 offset:53248
    v_mfma_f32_16x16x32_bf16 v[172:175], a[12:15], a[68:71], v[172:175]
    ds_read_b64_tr_b16 a[52:53], v53 offset:49152
    v_mfma_f32_16x16x32_bf16 v[164:167], a[12:15], a[64:67], v[164:167]
    ds_read_b64_tr_b16 a[54:55], v53 offset:53248
    v_mfma_f32_16x16x32_bf16 v[192:195], a[16:19], a[64:67], v[192:195]
    ds_read_b64_tr_b16 a[56:57], v54 offset:49152
    v_mfma_f32_16x16x32_bf16 v[200:203], a[16:19], a[68:71], v[200:203]
    ds_read_b64_tr_b16 a[58:59], v54 offset:53248
    v_mfma_f32_16x16x32_bf16 v[208:211], a[16:19], a[72:75], v[208:211]
    ds_read_b64_tr_b16 a[60:61], v55 offset:49152
    v_mfma_f32_16x16x32_bf16 v[216:219], a[16:19], a[76:79], v[216:219]
    ds_read_b64_tr_b16 a[62:63], v55 offset:53248
    v_mfma_f32_16x16x32_bf16 v[220:223], a[20:23], a[76:79], v[220:223]
    v_mfma_f32_16x16x32_bf16 v[212:215], a[20:23], a[72:75], v[212:215]
    v_mfma_f32_16x16x32_bf16 v[204:207], a[20:23], a[68:71], v[204:207]
    v_mfma_f32_16x16x32_bf16 v[196:199], a[20:23], a[64:67], v[196:199]
    v_mfma_f32_16x16x32_bf16 v[224:227], a[24:27], a[64:67], v[224:227]
    v_mfma_f32_16x16x32_bf16 v[232:235], a[24:27], a[68:71], v[232:235]
    v_mfma_f32_16x16x32_bf16 v[240:243], a[24:27], a[72:75], v[240:243]
    v_mfma_f32_16x16x32_bf16 v[248:251], a[24:27], a[76:79], v[248:251]
    v_mfma_f32_16x16x32_bf16 v[252:255], a[28:31], a[76:79], v[252:255]
    v_mfma_f32_16x16x32_bf16 v[244:247], a[28:31], a[72:75], v[244:247]
    v_mfma_f32_16x16x32_bf16 v[236:239], a[28:31], a[68:71], v[236:239]
    v_mfma_f32_16x16x32_bf16 v[228:231], a[28:31], a[64:67], v[228:231]
    s_add_u32 m0, s36, 0
    s_xor_b32 s33, s30, 1048576
    buffer_load_dwordx4 v4, s[52:55], s33 offen offset:0  lds
    buffer_load_dwordx4 v5, s[52:55], s33 offen offset:1024  lds
    buffer_load_dwordx4 v6, s[52:55], s33 offen offset:2048  lds
    buffer_load_dwordx4 v7, s[52:55], s33 offen offset:3072  lds
    s_add_u32 m0, s36, 16384
    s_xor_b32 s33, s30, 1310720
    buffer_load_dwordx4 v4, s[52:55], s33 offen offset:0  lds
    buffer_load_dwordx4 v5, s[52:55], s33 offen offset:1024  lds
    buffer_load_dwordx4 v6, s[52:55], s33 offen offset:2048  lds
    buffer_load_dwordx4 v7, s[52:55], s33 offen offset:3072  lds
    s_waitcnt vmcnt(4) lgkmcnt(0)
    s_barrier
    v_mfma_f32_16x16x32_bf16 v[128:131], a[32:35], a[80:83], v[128:131]
    ds_read_b128 a[64:67], v28 offset:32768
    s_add_u32 m0, s37, 147456
    v_mfma_f32_16x16x32_bf16 v[136:139], a[32:35], a[84:87], v[136:139]
    ds_read_b128 a[68:71], v28 offset:34816
    s_xor_b32 s33, s29, 384
    v_mfma_f32_16x16x32_bf16 v[144:147], a[32:35], a[88:91], v[144:147]
    buffer_load_dwordx4 v44, s[40:43], s33 offen offset:0  lds
    v_mfma_f32_16x16x32_bf16 v[152:155], a[32:35], a[92:95], v[152:155]
    ds_read_b128 a[72:75], v28 offset:36864
    v_mfma_f32_16x16x32_bf16 v[156:159], a[36:39], a[92:95], v[156:159]
    ds_read_b128 a[76:79], v28 offset:38912
    v_mfma_f32_16x16x32_bf16 v[148:151], a[36:39], a[88:91], v[148:151]
    ds_read_b64_tr_b16 a[0:1], v48 offset:0
    v_mfma_f32_16x16x32_bf16 v[140:143], a[36:39], a[84:87], v[140:143]
    buffer_load_dwordx4 v45, s[40:43], s33 offen offset:1024  lds
    v_mfma_f32_16x16x32_bf16 v[132:135], a[36:39], a[80:83], v[132:135]
    ds_read_b64_tr_b16 a[2:3], v48 offset:4096
    v_mfma_f32_16x16x32_bf16 v[160:163], a[40:43], a[80:83], v[160:163]
    ds_read_b64_tr_b16 a[4:5], v49 offset:0
    v_mfma_f32_16x16x32_bf16 v[168:171], a[40:43], a[84:87], v[168:171]
    ds_read_b64_tr_b16 a[6:7], v49 offset:4096
    v_mfma_f32_16x16x32_bf16 v[176:179], a[40:43], a[88:91], v[176:179]
    buffer_load_dwordx4 v46, s[40:43], s33 offen offset:2048  lds
    v_mfma_f32_16x16x32_bf16 v[184:187], a[40:43], a[92:95], v[184:187]
    ds_read_b64_tr_b16 a[8:9], v50 offset:0
    v_mfma_f32_16x16x32_bf16 v[188:191], a[44:47], a[92:95], v[188:191]
    ds_read_b64_tr_b16 a[10:11], v50 offset:4096
    v_mfma_f32_16x16x32_bf16 v[180:183], a[44:47], a[88:91], v[180:183]
    ds_read_b64_tr_b16 a[12:13], v51 offset:0
    v_mfma_f32_16x16x32_bf16 v[172:175], a[44:47], a[84:87], v[172:175]
    buffer_load_dwordx4 v47, s[40:43], s33 offen offset:3072  lds
    s_add_u32 m0, s36, 32768
    v_mfma_f32_16x16x32_bf16 v[164:167], a[44:47], a[80:83], v[164:167]
    ds_read_b64_tr_b16 a[14:15], v51 offset:4096
    s_xor_b32 s33, s30, 1572864
    v_mfma_f32_16x16x32_bf16 v[192:195], a[48:51], a[80:83], v[192:195]
    ds_read_b64_tr_b16 a[16:17], v52 offset:0
    v_mfma_f32_16x16x32_bf16 v[200:203], a[48:51], a[84:87], v[200:203]
    ds_read_b64_tr_b16 a[18:19], v52 offset:4096
    v_mfma_f32_16x16x32_bf16 v[208:211], a[48:51], a[88:91], v[208:211]
    buffer_load_dwordx4 v4, s[52:55], s33 offen offset:0  lds
    v_mfma_f32_16x16x32_bf16 v[216:219], a[48:51], a[92:95], v[216:219]
    ds_read_b64_tr_b16 a[20:21], v53 offset:0
    v_mfma_f32_16x16x32_bf16 v[220:223], a[52:55], a[92:95], v[220:223]
    ds_read_b64_tr_b16 a[22:23], v53 offset:4096
    v_mfma_f32_16x16x32_bf16 v[212:215], a[52:55], a[88:91], v[212:215]
    ds_read_b64_tr_b16 a[24:25], v54 offset:0
    v_mfma_f32_16x16x32_bf16 v[204:207], a[52:55], a[84:87], v[204:207]
    buffer_load_dwordx4 v5, s[52:55], s33 offen offset:1024  lds
    v_mfma_f32_16x16x32_bf16 v[196:199], a[52:55], a[80:83], v[196:199]
    ds_read_b64_tr_b16 a[26:27], v54 offset:4096
    v_mfma_f32_16x16x32_bf16 v[224:227], a[56:59], a[80:83], v[224:227]
    ds_read_b64_tr_b16 a[28:29], v55 offset:0
    v_mfma_f32_16x16x32_bf16 v[232:235], a[56:59], a[84:87], v[232:235]
    ds_read_b64_tr_b16 a[30:31], v55 offset:4096
    v_mfma_f32_16x16x32_bf16 v[240:243], a[56:59], a[88:91], v[240:243]
    buffer_load_dwordx4 v6, s[52:55], s33 offen offset:2048  lds
    v_mfma_f32_16x16x32_bf16 v[248:251], a[56:59], a[92:95], v[248:251]
    v_mfma_f32_16x16x32_bf16 v[252:255], a[60:63], a[92:95], v[252:255]
    v_mfma_f32_16x16x32_bf16 v[244:247], a[60:63], a[88:91], v[244:247]
    v_mfma_f32_16x16x32_bf16 v[236:239], a[60:63], a[84:87], v[236:239]
    buffer_load_dwordx4 v7, s[52:55], s33 offen offset:3072  lds
    v_mfma_f32_16x16x32_bf16 v[228:231], a[60:63], a[80:83], v[228:231]
    s_waitcnt vmcnt(8) lgkmcnt(0)
    s_barrier
    v_mfma_f32_16x16x32_bf16 v[128:131], a[0:3], a[64:67], v[128:131]
    ds_read_b128 a[80:83], v29 offset:32768
    s_add_u32 m0, s36, 49152
    v_mfma_f32_16x16x32_bf16 v[136:139], a[0:3], a[68:71], v[136:139]
    ds_read_b128 a[84:87], v29 offset:34816
    s_xor_b32 s33, s30, 1835008
    v_mfma_f32_16x16x32_bf16 v[144:147], a[0:3], a[72:75], v[144:147]
    buffer_load_dwordx4 v4, s[52:55], s33 offen offset:0  lds
    v_mfma_f32_16x16x32_bf16 v[152:155], a[0:3], a[76:79], v[152:155]
    ds_read_b128 a[88:91], v29 offset:36864
    ds_read_b128 a[92:95], v29 offset:38912
    v_mfma_f32_16x16x32_bf16 v[156:159], a[4:7], a[76:79], v[156:159]
    ds_read_b64_tr_b16 a[32:33], v48 offset:16384
    ds_read_b64_tr_b16 a[34:35], v48 offset:20480
    v_mfma_f32_16x16x32_bf16 v[148:151], a[4:7], a[72:75], v[148:151]
    ds_read_b64_tr_b16 a[36:37], v49 offset:16384
    ds_read_b64_tr_b16 a[38:39], v49 offset:20480
    v_mfma_f32_16x16x32_bf16 v[140:143], a[4:7], a[68:71], v[140:143]
    buffer_load_dwordx4 v5, s[52:55], s33 offen offset:1024  lds
    v_mfma_f32_16x16x32_bf16 v[132:135], a[4:7], a[64:67], v[132:135]
    ds_read_b64_tr_b16 a[40:41], v50 offset:16384
    ds_read_b64_tr_b16 a[42:43], v50 offset:20480
    v_mfma_f32_16x16x32_bf16 v[160:163], a[8:11], a[64:67], v[160:163]
    ds_read_b64_tr_b16 a[44:45], v51 offset:16384
    ds_read_b64_tr_b16 a[46:47], v51 offset:20480
    v_mfma_f32_16x16x32_bf16 v[168:171], a[8:11], a[68:71], v[168:171]
    ds_read_b64_tr_b16 a[48:49], v52 offset:16384
    ds_read_b64_tr_b16 a[50:51], v52 offset:20480
    v_mfma_f32_16x16x32_bf16 v[176:179], a[8:11], a[72:75], v[176:179]
    buffer_load_dwordx4 v6, s[52:55], s33 offen offset:2048  lds
    v_mfma_f32_16x16x32_bf16 v[184:187], a[8:11], a[76:79], v[184:187]
    ds_read_b64_tr_b16 a[52:53], v53 offset:16384
    ds_read_b64_tr_b16 a[54:55], v53 offset:20480
    v_mfma_f32_16x16x32_bf16 v[188:191], a[12:15], a[76:79], v[188:191]
    ds_read_b64_tr_b16 a[56:57], v54 offset:16384
    ds_read_b64_tr_b16 a[58:59], v54 offset:20480
    v_mfma_f32_16x16x32_bf16 v[180:183], a[12:15], a[72:75], v[180:183]
    ds_read_b64_tr_b16 a[60:61], v55 offset:16384
    ds_read_b64_tr_b16 a[62:63], v55 offset:20480
    v_mfma_f32_16x16x32_bf16 v[172:175], a[12:15], a[68:71], v[172:175]
    buffer_load_dwordx4 v7, s[52:55], s33 offen offset:3072  lds
    s_add_u32 m0, s37, 98304
    v_mfma_f32_16x16x32_bf16 v[164:167], a[12:15], a[64:67], v[164:167]
    ds_read_b64 a[128:129], v32 offset:0
    s_xor_b32 s33, s29, 768
    v_mfma_f32_16x16x32_bf16 v[192:195], a[16:19], a[64:67], v[192:195]
    ds_read_b64 a[144:145], v32 offset:4096
    ds_read_b64 a[130:131], v33 offset:0
    v_mfma_f32_16x16x32_bf16 v[200:203], a[16:19], a[68:71], v[200:203]
    ds_read_b64 a[146:147], v33 offset:4096
    ds_read_b64 a[132:133], v34 offset:0
    v_mfma_f32_16x16x32_bf16 v[208:211], a[16:19], a[72:75], v[208:211]
    buffer_load_dwordx4 v44, s[40:43], s33 offen offset:0  lds
    v_mfma_f32_16x16x32_bf16 v[216:219], a[16:19], a[76:79], v[216:219]
    ds_read_b64 a[148:149], v34 offset:4096
    ds_read_b64 a[134:135], v35 offset:0
    v_mfma_f32_16x16x32_bf16 v[220:223], a[20:23], a[76:79], v[220:223]
    ds_read_b64 a[150:151], v35 offset:4096
    ds_read_b64 a[136:137], v36 offset:0
    v_mfma_f32_16x16x32_bf16 v[212:215], a[20:23], a[72:75], v[212:215]
    ds_read_b64 a[152:153], v36 offset:4096
    ds_read_b64 a[138:139], v37 offset:0
    v_mfma_f32_16x16x32_bf16 v[204:207], a[20:23], a[68:71], v[204:207]
    buffer_load_dwordx4 v45, s[40:43], s33 offen offset:1024  lds
    v_mfma_f32_16x16x32_bf16 v[196:199], a[20:23], a[64:67], v[196:199]
    ds_read_b64 a[154:155], v37 offset:4096
    ds_read_b64 a[140:141], v38 offset:0
    v_mfma_f32_16x16x32_bf16 v[224:227], a[24:27], a[64:67], v[224:227]
    ds_read_b64 a[156:157], v38 offset:4096
    v_mfma_f32_16x16x32_bf16 v[232:235], a[24:27], a[68:71], v[232:235]
    ds_read_b64 a[142:143], v39 offset:0
    v_mfma_f32_16x16x32_bf16 v[240:243], a[24:27], a[72:75], v[240:243]
    buffer_load_dwordx4 v46, s[40:43], s33 offen offset:2048  lds
    v_mfma_f32_16x16x32_bf16 v[248:251], a[24:27], a[76:79], v[248:251]
    ds_read_b64 a[158:159], v39 offset:4096
    v_mfma_f32_16x16x32_bf16 v[252:255], a[28:31], a[76:79], v[252:255]
    v_mfma_f32_16x16x32_bf16 v[244:247], a[28:31], a[72:75], v[244:247]
    v_mfma_f32_16x16x32_bf16 v[236:239], a[28:31], a[68:71], v[236:239]
    buffer_load_dwordx4 v47, s[40:43], s33 offen offset:3072  lds
    v_mfma_f32_16x16x32_bf16 v[228:231], a[28:31], a[64:67], v[228:231]
    s_waitcnt vmcnt(8) lgkmcnt(0)
    s_barrier
    v_mfma_f32_16x16x32_bf16 v[128:131], a[32:35], a[80:83], v[128:131]
    ds_read_b128 a[64:67], v28 offset:49152
    s_add_u32 m0, s36, 0
    v_mfma_f32_16x16x32_bf16 v[136:139], a[32:35], a[84:87], v[136:139]
    ds_read_b128 a[68:71], v28 offset:51200
    s_xor_b32 s33, s30, 3145728
    v_mfma_f32_16x16x32_bf16 v[144:147], a[32:35], a[88:91], v[144:147]
    buffer_load_dwordx4 v4, s[52:55], s33 offen offset:0  lds
    v_mfma_f32_16x16x32_bf16 v[152:155], a[32:35], a[92:95], v[152:155]
    ds_read_b128 a[72:75], v28 offset:53248
    v_mfma_f32_16x16x32_bf16 v[156:159], a[36:39], a[92:95], v[156:159]
    ds_read_b128 a[76:79], v28 offset:55296
    v_mfma_f32_16x16x32_bf16 v[148:151], a[36:39], a[88:91], v[148:151]
    ds_read_b64_tr_b16 a[0:1], v48 offset:32768
    v_mfma_f32_16x16x32_bf16 v[140:143], a[36:39], a[84:87], v[140:143]
    buffer_load_dwordx4 v5, s[52:55], s33 offen offset:1024  lds
    v_mfma_f32_16x16x32_bf16 v[132:135], a[36:39], a[80:83], v[132:135]
    ds_read_b64_tr_b16 a[2:3], v48 offset:36864
    v_mfma_f32_16x16x32_bf16 v[160:163], a[40:43], a[80:83], v[160:163]
    ds_read_b64_tr_b16 a[4:5], v49 offset:32768
    v_mfma_f32_16x16x32_bf16 v[168:171], a[40:43], a[84:87], v[168:171]
    ds_read_b64_tr_b16 a[6:7], v49 offset:36864
    v_mfma_f32_16x16x32_bf16 v[176:179], a[40:43], a[88:91], v[176:179]
    buffer_load_dwordx4 v6, s[52:55], s33 offen offset:2048  lds
    v_mfma_f32_16x16x32_bf16 v[184:187], a[40:43], a[92:95], v[184:187]
    ds_read_b64_tr_b16 a[8:9], v50 offset:32768
    v_mfma_f32_16x16x32_bf16 v[188:191], a[44:47], a[92:95], v[188:191]
    ds_read_b64_tr_b16 a[10:11], v50 offset:36864
    v_mfma_f32_16x16x32_bf16 v[180:183], a[44:47], a[88:91], v[180:183]
    ds_read_b64_tr_b16 a[12:13], v51 offset:32768
    v_mfma_f32_16x16x32_bf16 v[172:175], a[44:47], a[84:87], v[172:175]
    buffer_load_dwordx4 v7, s[52:55], s33 offen offset:3072  lds
    v_mfma_f32_16x16x32_bf16 v[164:167], a[44:47], a[80:83], v[164:167]
    ds_read_b64_tr_b16 a[14:15], v51 offset:36864
    v_mfma_f32_16x16x32_bf16 v[192:195], a[48:51], a[80:83], v[192:195]
    ds_read_b64_tr_b16 a[16:17], v52 offset:32768
    v_mfma_f32_16x16x32_bf16 v[200:203], a[48:51], a[84:87], v[200:203]
    ds_read_b64_tr_b16 a[18:19], v52 offset:36864
    v_mfma_f32_16x16x32_bf16 v[208:211], a[48:51], a[88:91], v[208:211]
    ds_read_b64_tr_b16 a[20:21], v53 offset:32768
    v_mfma_f32_16x16x32_bf16 v[216:219], a[48:51], a[92:95], v[216:219]
    ds_read_b64_tr_b16 a[22:23], v53 offset:36864
    v_mfma_f32_16x16x32_bf16 v[220:223], a[52:55], a[92:95], v[220:223]
    ds_read_b64_tr_b16 a[24:25], v54 offset:32768
    v_mfma_f32_16x16x32_bf16 v[212:215], a[52:55], a[88:91], v[212:215]
    ds_read_b64_tr_b16 a[26:27], v54 offset:36864
    v_mfma_f32_16x16x32_bf16 v[204:207], a[52:55], a[84:87], v[204:207]
    ds_read_b64_tr_b16 a[28:29], v55 offset:32768
    v_mfma_f32_16x16x32_bf16 v[196:199], a[52:55], a[80:83], v[196:199]
    ds_read_b64_tr_b16 a[30:31], v55 offset:36864
    v_mfma_f32_16x16x32_bf16 v[224:227], a[56:59], a[80:83], v[224:227]
    v_mfma_f32_16x16x32_bf16 v[232:235], a[56:59], a[84:87], v[232:235]
    v_mfma_f32_16x16x32_bf16 v[240:243], a[56:59], a[88:91], v[240:243]
    v_mfma_f32_16x16x32_bf16 v[248:251], a[56:59], a[92:95], v[248:251]
    v_mfma_f32_16x16x32_bf16 v[252:255], a[60:63], a[92:95], v[252:255]
    v_mfma_f32_16x16x32_bf16 v[244:247], a[60:63], a[88:91], v[244:247]
    v_mfma_f32_16x16x32_bf16 v[236:239], a[60:63], a[84:87], v[236:239]
    v_mfma_f32_16x16x32_bf16 v[228:231], a[60:63], a[80:83], v[228:231]
    s_waitcnt vmcnt(8) lgkmcnt(0)
    s_barrier
    v_mfma_f32_16x16x32_bf16 v[128:131], a[0:3], a[64:67], v[128:131]
    ds_read_b128 a[80:83], v29 offset:49152
    v_mfma_f32_16x16x32_bf16 v[136:139], a[0:3], a[68:71], v[136:139]
    ds_read_b128 a[84:87], v29 offset:51200
    v_mfma_f32_16x16x32_bf16 v[144:147], a[0:3], a[72:75], v[144:147]
    ds_read_b128 a[88:91], v29 offset:53248
    v_mfma_f32_16x16x32_bf16 v[152:155], a[0:3], a[76:79], v[152:155]
    ds_read_b128 a[92:95], v29 offset:55296
    v_mfma_f32_16x16x32_bf16 v[156:159], a[4:7], a[76:79], v[156:159]
    ds_read_b64_tr_b16 a[32:33], v48 offset:49152
    v_mfma_f32_16x16x32_bf16 v[148:151], a[4:7], a[72:75], v[148:151]
    ds_read_b64_tr_b16 a[34:35], v48 offset:53248
    v_mfma_f32_16x16x32_bf16 v[140:143], a[4:7], a[68:71], v[140:143]
    ds_read_b64_tr_b16 a[36:37], v49 offset:49152
    v_mfma_f32_16x16x32_bf16 v[132:135], a[4:7], a[64:67], v[132:135]
    ds_read_b64_tr_b16 a[38:39], v49 offset:53248
    v_mfma_f32_16x16x32_bf16 v[160:163], a[8:11], a[64:67], v[160:163]
    ds_read_b64_tr_b16 a[40:41], v50 offset:49152
    v_mfma_f32_16x16x32_bf16 v[168:171], a[8:11], a[68:71], v[168:171]
    ds_read_b64_tr_b16 a[42:43], v50 offset:53248
    v_mfma_f32_16x16x32_bf16 v[176:179], a[8:11], a[72:75], v[176:179]
    ds_read_b64_tr_b16 a[44:45], v51 offset:49152
    v_mfma_f32_16x16x32_bf16 v[184:187], a[8:11], a[76:79], v[184:187]
    ds_read_b64_tr_b16 a[46:47], v51 offset:53248
    v_mfma_f32_16x16x32_bf16 v[188:191], a[12:15], a[76:79], v[188:191]
    ds_read_b64_tr_b16 a[48:49], v52 offset:49152
    v_mfma_f32_16x16x32_bf16 v[180:183], a[12:15], a[72:75], v[180:183]
    ds_read_b64_tr_b16 a[50:51], v52 offset:53248
    s_add_u32 m0, s36, 16384
    v_mfma_f32_16x16x32_bf16 v[172:175], a[12:15], a[68:71], v[172:175]
    ds_read_b64_tr_b16 a[52:53], v53 offset:49152
    s_xor_b32 s33, s30, 3407872
    v_mfma_f32_16x16x32_bf16 v[164:167], a[12:15], a[64:67], v[164:167]
    ds_read_b64_tr_b16 a[54:55], v53 offset:53248
    v_mfma_f32_16x16x32_bf16 v[192:195], a[16:19], a[64:67], v[192:195]
    buffer_load_dwordx4 v4, s[52:55], s33 offen offset:0  lds
    v_mfma_f32_16x16x32_bf16 v[200:203], a[16:19], a[68:71], v[200:203]
    ds_read_b64_tr_b16 a[56:57], v54 offset:49152
    v_mfma_f32_16x16x32_bf16 v[208:211], a[16:19], a[72:75], v[208:211]
    ds_read_b64_tr_b16 a[58:59], v54 offset:53248
    v_mfma_f32_16x16x32_bf16 v[216:219], a[16:19], a[76:79], v[216:219]
    ds_read_b64_tr_b16 a[60:61], v55 offset:49152
    v_mfma_f32_16x16x32_bf16 v[220:223], a[20:23], a[76:79], v[220:223]
    buffer_load_dwordx4 v5, s[52:55], s33 offen offset:1024  lds
    v_mfma_f32_16x16x32_bf16 v[212:215], a[20:23], a[72:75], v[212:215]
    ds_read_b64_tr_b16 a[62:63], v55 offset:53248
    v_mfma_f32_16x16x32_bf16 v[204:207], a[20:23], a[68:71], v[204:207]
    v_mfma_f32_16x16x32_bf16 v[196:199], a[20:23], a[64:67], v[196:199]
    v_mfma_f32_16x16x32_bf16 v[224:227], a[24:27], a[64:67], v[224:227]
    buffer_load_dwordx4 v6, s[52:55], s33 offen offset:2048  lds
    v_mfma_f32_16x16x32_bf16 v[232:235], a[24:27], a[68:71], v[232:235]
    v_mfma_f32_16x16x32_bf16 v[240:243], a[24:27], a[72:75], v[240:243]
    v_mfma_f32_16x16x32_bf16 v[248:251], a[24:27], a[76:79], v[248:251]
    v_mfma_f32_16x16x32_bf16 v[252:255], a[28:31], a[76:79], v[252:255]
    buffer_load_dwordx4 v7, s[52:55], s33 offen offset:3072  lds
    v_mfma_f32_16x16x32_bf16 v[244:247], a[28:31], a[72:75], v[244:247]
    v_mfma_f32_16x16x32_bf16 v[236:239], a[28:31], a[68:71], v[236:239]
    v_mfma_f32_16x16x32_bf16 v[228:231], a[28:31], a[64:67], v[228:231]
    s_waitcnt vmcnt(4) lgkmcnt(0)
    s_barrier
    v_mfma_f32_16x16x32_bf16 v[128:131], a[32:35], a[80:83], v[128:131]
    ds_read_b128 a[64:67], v28 offset:0
    s_add_u32 m0, s37, 114688
    v_mfma_f32_16x16x32_bf16 v[136:139], a[32:35], a[84:87], v[136:139]
    ds_read_b128 a[68:71], v28 offset:2048
    s_xor_b32 s33, s29, 896
    v_mfma_f32_16x16x32_bf16 v[144:147], a[32:35], a[88:91], v[144:147]
    buffer_load_dwordx4 v44, s[40:43], s33 offen offset:0  lds
    v_mfma_f32_16x16x32_bf16 v[152:155], a[32:35], a[92:95], v[152:155]
    ds_read_b128 a[72:75], v28 offset:4096
    v_mfma_f32_16x16x32_bf16 v[156:159], a[36:39], a[92:95], v[156:159]
    ds_read_b128 a[76:79], v28 offset:6144
    v_mfma_f32_16x16x32_bf16 v[148:151], a[36:39], a[88:91], v[148:151]
    ds_read_b64_tr_b16 a[0:1], v48 offset:0
    v_mfma_f32_16x16x32_bf16 v[140:143], a[36:39], a[84:87], v[140:143]
    buffer_load_dwordx4 v45, s[40:43], s33 offen offset:1024  lds
    v_mfma_f32_16x16x32_bf16 v[132:135], a[36:39], a[80:83], v[132:135]
    ds_read_b64_tr_b16 a[2:3], v48 offset:4096
    v_mfma_f32_16x16x32_bf16 v[160:163], a[40:43], a[80:83], v[160:163]
    ds_read_b64_tr_b16 a[4:5], v49 offset:0
    v_mfma_f32_16x16x32_bf16 v[168:171], a[40:43], a[84:87], v[168:171]
    ds_read_b64_tr_b16 a[6:7], v49 offset:4096
    v_mfma_f32_16x16x32_bf16 v[176:179], a[40:43], a[88:91], v[176:179]
    buffer_load_dwordx4 v46, s[40:43], s33 offen offset:2048  lds
    v_mfma_f32_16x16x32_bf16 v[184:187], a[40:43], a[92:95], v[184:187]
    ds_read_b64_tr_b16 a[8:9], v50 offset:0
    v_mfma_f32_16x16x32_bf16 v[188:191], a[44:47], a[92:95], v[188:191]
    ds_read_b64_tr_b16 a[10:11], v50 offset:4096
    v_mfma_f32_16x16x32_bf16 v[180:183], a[44:47], a[88:91], v[180:183]
    ds_read_b64_tr_b16 a[12:13], v51 offset:0
    v_mfma_f32_16x16x32_bf16 v[172:175], a[44:47], a[84:87], v[172:175]
    buffer_load_dwordx4 v47, s[40:43], s33 offen offset:3072  lds
    s_add_u32 m0, s36, 32768
    v_mfma_f32_16x16x32_bf16 v[164:167], a[44:47], a[80:83], v[164:167]
    ds_read_b64_tr_b16 a[14:15], v51 offset:4096
    s_xor_b32 s33, s30, 3670016
    v_mfma_f32_16x16x32_bf16 v[192:195], a[48:51], a[80:83], v[192:195]
    ds_read_b64_tr_b16 a[16:17], v52 offset:0
    v_mfma_f32_16x16x32_bf16 v[200:203], a[48:51], a[84:87], v[200:203]
    ds_read_b64_tr_b16 a[18:19], v52 offset:4096
    v_mfma_f32_16x16x32_bf16 v[208:211], a[48:51], a[88:91], v[208:211]
    buffer_load_dwordx4 v4, s[52:55], s33 offen offset:0  lds
    v_mfma_f32_16x16x32_bf16 v[216:219], a[48:51], a[92:95], v[216:219]
    ds_read_b64_tr_b16 a[20:21], v53 offset:0
    v_mfma_f32_16x16x32_bf16 v[220:223], a[52:55], a[92:95], v[220:223]
    ds_read_b64_tr_b16 a[22:23], v53 offset:4096
    v_mfma_f32_16x16x32_bf16 v[212:215], a[52:55], a[88:91], v[212:215]
    ds_read_b64_tr_b16 a[24:25], v54 offset:0
    v_mfma_f32_16x16x32_bf16 v[204:207], a[52:55], a[84:87], v[204:207]
    buffer_load_dwordx4 v5, s[52:55], s33 offen offset:1024  lds
    v_mfma_f32_16x16x32_bf16 v[196:199], a[52:55], a[80:83], v[196:199]
    ds_read_b64_tr_b16 a[26:27], v54 offset:4096
    v_mfma_f32_16x16x32_bf16 v[224:227], a[56:59], a[80:83], v[224:227]
    ds_read_b64_tr_b16 a[28:29], v55 offset:0
    v_mfma_f32_16x16x32_bf16 v[232:235], a[56:59], a[84:87], v[232:235]
    ds_read_b64_tr_b16 a[30:31], v55 offset:4096
    v_mfma_f32_16x16x32_bf16 v[240:243], a[56:59], a[88:91], v[240:243]
    buffer_load_dwordx4 v6, s[52:55], s33 offen offset:2048  lds
    v_mfma_f32_16x16x32_bf16 v[248:251], a[56:59], a[92:95], v[248:251]
    v_mfma_f32_16x16x32_bf16 v[252:255], a[60:63], a[92:95], v[252:255]
    v_mfma_f32_16x16x32_bf16 v[244:247], a[60:63], a[88:91], v[244:247]
    v_mfma_f32_16x16x32_bf16 v[236:239], a[60:63], a[84:87], v[236:239]
    buffer_load_dwordx4 v7, s[52:55], s33 offen offset:3072  lds
    v_mfma_f32_16x16x32_bf16 v[228:231], a[60:63], a[80:83], v[228:231]
    s_waitcnt vmcnt(8) lgkmcnt(0)
    s_barrier
    v_mfma_f32_16x16x32_bf16 v[128:131], a[0:3], a[64:67], v[128:131]
    ds_read_b128 a[80:83], v29 offset:0
    s_add_u32 m0, s36, 49152
    v_mfma_f32_16x16x32_bf16 v[136:139], a[0:3], a[68:71], v[136:139]
    ds_read_b128 a[84:87], v29 offset:2048
    s_xor_b32 s33, s30, 3932160
    v_mfma_f32_16x16x32_bf16 v[144:147], a[0:3], a[72:75], v[144:147]
    buffer_load_dwordx4 v4, s[52:55], s33 offen offset:0  lds
    v_mfma_f32_16x16x32_bf16 v[152:155], a[0:3], a[76:79], v[152:155]
    ds_read_b128 a[88:91], v29 offset:4096
    v_mfma_f32_16x16x32_bf16 v[156:159], a[4:7], a[76:79], v[156:159]
    ds_read_b128 a[92:95], v29 offset:6144
    v_mfma_f32_16x16x32_bf16 v[148:151], a[4:7], a[72:75], v[148:151]
    ds_read_b64_tr_b16 a[32:33], v48 offset:16384
    v_mfma_f32_16x16x32_bf16 v[140:143], a[4:7], a[68:71], v[140:143]
    buffer_load_dwordx4 v5, s[52:55], s33 offen offset:1024  lds
    v_mfma_f32_16x16x32_bf16 v[132:135], a[4:7], a[64:67], v[132:135]
    ds_read_b64_tr_b16 a[34:35], v48 offset:20480
    v_mfma_f32_16x16x32_bf16 v[160:163], a[8:11], a[64:67], v[160:163]
    ds_read_b64_tr_b16 a[36:37], v49 offset:16384
    v_mfma_f32_16x16x32_bf16 v[168:171], a[8:11], a[68:71], v[168:171]
    ds_read_b64_tr_b16 a[38:39], v49 offset:20480
    v_mfma_f32_16x16x32_bf16 v[176:179], a[8:11], a[72:75], v[176:179]
    buffer_load_dwordx4 v6, s[52:55], s33 offen offset:2048  lds
    v_mfma_f32_16x16x32_bf16 v[184:187], a[8:11], a[76:79], v[184:187]
    ds_read_b64_tr_b16 a[40:41], v50 offset:16384
    v_mfma_f32_16x16x32_bf16 v[188:191], a[12:15], a[76:79], v[188:191]
    ds_read_b64_tr_b16 a[42:43], v50 offset:20480
    v_mfma_f32_16x16x32_bf16 v[180:183], a[12:15], a[72:75], v[180:183]
    ds_read_b64_tr_b16 a[44:45], v51 offset:16384
    v_mfma_f32_16x16x32_bf16 v[172:175], a[12:15], a[68:71], v[172:175]
    buffer_load_dwordx4 v7, s[52:55], s33 offen offset:3072  lds
    s_add_u32 m0, s37, 131072
    v_mfma_f32_16x16x32_bf16 v[164:167], a[12:15], a[64:67], v[164:167]
    ds_read_b64_tr_b16 a[46:47], v51 offset:20480
    s_xor_b32 s33, s29, 512
    v_mfma_f32_16x16x32_bf16 v[192:195], a[16:19], a[64:67], v[192:195]
    ds_read_b64_tr_b16 a[48:49], v52 offset:16384
    v_mfma_f32_16x16x32_bf16 v[200:203], a[16:19], a[68:71], v[200:203]
    ds_read_b64_tr_b16 a[50:51], v52 offset:20480
    v_mfma_f32_16x16x32_bf16 v[208:211], a[16:19], a[72:75], v[208:211]
    buffer_load_dwordx4 v44, s[40:43], s33 offen offset:0  lds
    v_mfma_f32_16x16x32_bf16 v[216:219], a[16:19], a[76:79], v[216:219]
    ds_read_b64_tr_b16 a[52:53], v53 offset:16384
    v_mfma_f32_16x16x32_bf16 v[220:223], a[20:23], a[76:79], v[220:223]
    ds_read_b64_tr_b16 a[54:55], v53 offset:20480
    v_mfma_f32_16x16x32_bf16 v[212:215], a[20:23], a[72:75], v[212:215]
    ds_read_b64_tr_b16 a[56:57], v54 offset:16384
    v_mfma_f32_16x16x32_bf16 v[204:207], a[20:23], a[68:71], v[204:207]
    buffer_load_dwordx4 v45, s[40:43], s33 offen offset:1024  lds
    v_mfma_f32_16x16x32_bf16 v[196:199], a[20:23], a[64:67], v[196:199]
    ds_read_b64_tr_b16 a[58:59], v54 offset:20480
    v_mfma_f32_16x16x32_bf16 v[224:227], a[24:27], a[64:67], v[224:227]
    ds_read_b64_tr_b16 a[60:61], v55 offset:16384
    v_mfma_f32_16x16x32_bf16 v[232:235], a[24:27], a[68:71], v[232:235]
    ds_read_b64_tr_b16 a[62:63], v55 offset:20480
    v_mfma_f32_16x16x32_bf16 v[240:243], a[24:27], a[72:75], v[240:243]
    buffer_load_dwordx4 v46, s[40:43], s33 offen offset:2048  lds
    v_mfma_f32_16x16x32_bf16 v[248:251], a[24:27], a[76:79], v[248:251]
    v_mfma_f32_16x16x32_bf16 v[252:255], a[28:31], a[76:79], v[252:255]
    v_mfma_f32_16x16x32_bf16 v[244:247], a[28:31], a[72:75], v[244:247]
    v_mfma_f32_16x16x32_bf16 v[236:239], a[28:31], a[68:71], v[236:239]
    buffer_load_dwordx4 v47, s[40:43], s33 offen offset:3072  lds
    v_mfma_f32_16x16x32_bf16 v[228:231], a[28:31], a[64:67], v[228:231]
    s_waitcnt vmcnt(8) lgkmcnt(0)
    s_barrier
    v_mfma_f32_16x16x32_bf16 v[128:131], a[32:35], a[80:83], v[128:131]
    ds_read_b128 a[64:67], v28 offset:16384
    s_add_u32 m0, s36, 0
    v_mfma_f32_16x16x32_bf16 v[136:139], a[32:35], a[84:87], v[136:139]
    ds_read_b128 a[68:71], v28 offset:18432
    s_xor_b32 s33, s30, 2097152
    v_mfma_f32_16x16x32_bf16 v[144:147], a[32:35], a[88:91], v[144:147]
    buffer_load_dwordx4 v4, s[52:55], s33 offen offset:0  lds
    v_mfma_f32_16x16x32_bf16 v[152:155], a[32:35], a[92:95], v[152:155]
    ds_read_b128 a[72:75], v28 offset:20480
    v_mfma_f32_16x16x32_bf16 v[156:159], a[36:39], a[92:95], v[156:159]
    ds_read_b128 a[76:79], v28 offset:22528
    v_mfma_f32_16x16x32_bf16 v[148:151], a[36:39], a[88:91], v[148:151]
    ds_read_b64_tr_b16 a[0:1], v48 offset:32768
    v_mfma_f32_16x16x32_bf16 v[140:143], a[36:39], a[84:87], v[140:143]
    buffer_load_dwordx4 v5, s[52:55], s33 offen offset:1024  lds
    v_mfma_f32_16x16x32_bf16 v[132:135], a[36:39], a[80:83], v[132:135]
    ds_read_b64_tr_b16 a[2:3], v48 offset:36864
    v_mfma_f32_16x16x32_bf16 v[160:163], a[40:43], a[80:83], v[160:163]
    ds_read_b64_tr_b16 a[4:5], v49 offset:32768
    v_mfma_f32_16x16x32_bf16 v[168:171], a[40:43], a[84:87], v[168:171]
    ds_read_b64_tr_b16 a[6:7], v49 offset:36864
    v_mfma_f32_16x16x32_bf16 v[176:179], a[40:43], a[88:91], v[176:179]
    buffer_load_dwordx4 v6, s[52:55], s33 offen offset:2048  lds
    v_mfma_f32_16x16x32_bf16 v[184:187], a[40:43], a[92:95], v[184:187]
    ds_read_b64_tr_b16 a[8:9], v50 offset:32768
    v_mfma_f32_16x16x32_bf16 v[188:191], a[44:47], a[92:95], v[188:191]
    ds_read_b64_tr_b16 a[10:11], v50 offset:36864
    v_mfma_f32_16x16x32_bf16 v[180:183], a[44:47], a[88:91], v[180:183]
    ds_read_b64_tr_b16 a[12:13], v51 offset:32768
    v_mfma_f32_16x16x32_bf16 v[172:175], a[44:47], a[84:87], v[172:175]
    buffer_load_dwordx4 v7, s[52:55], s33 offen offset:3072  lds
    s_add_u32 m0, s36, 16384
    v_mfma_f32_16x16x32_bf16 v[164:167], a[44:47], a[80:83], v[164:167]
    ds_read_b64_tr_b16 a[14:15], v51 offset:36864
    s_xor_b32 s33, s30, 2359296
    v_mfma_f32_16x16x32_bf16 v[192:195], a[48:51], a[80:83], v[192:195]
    ds_read_b64_tr_b16 a[16:17], v52 offset:32768
    v_mfma_f32_16x16x32_bf16 v[200:203], a[48:51], a[84:87], v[200:203]
    ds_read_b64_tr_b16 a[18:19], v52 offset:36864
    v_mfma_f32_16x16x32_bf16 v[208:211], a[48:51], a[88:91], v[208:211]
    buffer_load_dwordx4 v4, s[52:55], s33 offen offset:0  lds
    v_mfma_f32_16x16x32_bf16 v[216:219], a[48:51], a[92:95], v[216:219]
    ds_read_b64_tr_b16 a[20:21], v53 offset:32768
    v_mfma_f32_16x16x32_bf16 v[220:223], a[52:55], a[92:95], v[220:223]
    ds_read_b64_tr_b16 a[22:23], v53 offset:36864
    v_mfma_f32_16x16x32_bf16 v[212:215], a[52:55], a[88:91], v[212:215]
    ds_read_b64_tr_b16 a[24:25], v54 offset:32768
    v_mfma_f32_16x16x32_bf16 v[204:207], a[52:55], a[84:87], v[204:207]
    buffer_load_dwordx4 v5, s[52:55], s33 offen offset:1024  lds
    v_mfma_f32_16x16x32_bf16 v[196:199], a[52:55], a[80:83], v[196:199]
    ds_read_b64_tr_b16 a[26:27], v54 offset:36864
    v_mfma_f32_16x16x32_bf16 v[224:227], a[56:59], a[80:83], v[224:227]
    ds_read_b64_tr_b16 a[28:29], v55 offset:32768
    v_mfma_f32_16x16x32_bf16 v[232:235], a[56:59], a[84:87], v[232:235]
    ds_read_b64_tr_b16 a[30:31], v55 offset:36864
    v_mfma_f32_16x16x32_bf16 v[240:243], a[56:59], a[88:91], v[240:243]
    buffer_load_dwordx4 v6, s[52:55], s33 offen offset:2048  lds
    v_mfma_f32_16x16x32_bf16 v[248:251], a[56:59], a[92:95], v[248:251]
    v_mfma_f32_16x16x32_bf16 v[252:255], a[60:63], a[92:95], v[252:255]
    v_mfma_f32_16x16x32_bf16 v[244:247], a[60:63], a[88:91], v[244:247]
    v_mfma_f32_16x16x32_bf16 v[236:239], a[60:63], a[84:87], v[236:239]
    buffer_load_dwordx4 v7, s[52:55], s33 offen offset:3072  lds
    v_mfma_f32_16x16x32_bf16 v[228:231], a[60:63], a[80:83], v[228:231]
    s_waitcnt vmcnt(12) lgkmcnt(0)
    s_barrier
    v_mfma_f32_16x16x32_bf16 v[128:131], a[0:3], a[64:67], v[128:131]
    ds_read_b128 a[80:83], v29 offset:16384
    s_add_u32 m0, s37, 147456
    v_mfma_f32_16x16x32_bf16 v[136:139], a[0:3], a[68:71], v[136:139]
    ds_read_b128 a[84:87], v29 offset:18432
    s_xor_b32 s33, s29, 640
    v_mfma_f32_16x16x32_bf16 v[144:147], a[0:3], a[72:75], v[144:147]
    buffer_load_dwordx4 v44, s[40:43], s33 offen offset:0  lds
    v_mfma_f32_16x16x32_bf16 v[152:155], a[0:3], a[76:79], v[152:155]
    ds_read_b128 a[88:91], v29 offset:20480
    v_mfma_f32_16x16x32_bf16 v[156:159], a[4:7], a[76:79], v[156:159]
    ds_read_b128 a[92:95], v29 offset:22528
    v_mfma_f32_16x16x32_bf16 v[148:151], a[4:7], a[72:75], v[148:151]
    ds_read_b64_tr_b16 a[32:33], v48 offset:49152
    v_mfma_f32_16x16x32_bf16 v[140:143], a[4:7], a[68:71], v[140:143]
    buffer_load_dwordx4 v45, s[40:43], s33 offen offset:1024  lds
    v_mfma_f32_16x16x32_bf16 v[132:135], a[4:7], a[64:67], v[132:135]
    ds_read_b64_tr_b16 a[34:35], v48 offset:53248
    v_mfma_f32_16x16x32_bf16 v[160:163], a[8:11], a[64:67], v[160:163]
    ds_read_b64_tr_b16 a[36:37], v49 offset:49152
    v_mfma_f32_16x16x32_bf16 v[168:171], a[8:11], a[68:71], v[168:171]
    ds_read_b64_tr_b16 a[38:39], v49 offset:53248
    v_mfma_f32_16x16x32_bf16 v[176:179], a[8:11], a[72:75], v[176:179]
    buffer_load_dwordx4 v46, s[40:43], s33 offen offset:2048  lds
    v_mfma_f32_16x16x32_bf16 v[184:187], a[8:11], a[76:79], v[184:187]
    ds_read_b64_tr_b16 a[40:41], v50 offset:49152
    v_mfma_f32_16x16x32_bf16 v[188:191], a[12:15], a[76:79], v[188:191]
    ds_read_b64_tr_b16 a[42:43], v50 offset:53248
    v_mfma_f32_16x16x32_bf16 v[180:183], a[12:15], a[72:75], v[180:183]
    ds_read_b64_tr_b16 a[44:45], v51 offset:49152
    v_mfma_f32_16x16x32_bf16 v[172:175], a[12:15], a[68:71], v[172:175]
    buffer_load_dwordx4 v47, s[40:43], s33 offen offset:3072  lds
    s_add_u32 m0, s36, 32768
    v_mfma_f32_16x16x32_bf16 v[164:167], a[12:15], a[64:67], v[164:167]
    ds_read_b64_tr_b16 a[46:47], v51 offset:53248
    s_xor_b32 s33, s30, 2621440
    v_mfma_f32_16x16x32_bf16 v[192:195], a[16:19], a[64:67], v[192:195]
    ds_read_b64_tr_b16 a[48:49], v52 offset:49152
    v_mfma_f32_16x16x32_bf16 v[200:203], a[16:19], a[68:71], v[200:203]
    ds_read_b64_tr_b16 a[50:51], v52 offset:53248
    v_mfma_f32_16x16x32_bf16 v[208:211], a[16:19], a[72:75], v[208:211]
    buffer_load_dwordx4 v4, s[52:55], s33 offen offset:0  lds
    v_mfma_f32_16x16x32_bf16 v[216:219], a[16:19], a[76:79], v[216:219]
    ds_read_b64_tr_b16 a[52:53], v53 offset:49152
    v_mfma_f32_16x16x32_bf16 v[220:223], a[20:23], a[76:79], v[220:223]
    ds_read_b64_tr_b16 a[54:55], v53 offset:53248
    v_mfma_f32_16x16x32_bf16 v[212:215], a[20:23], a[72:75], v[212:215]
    ds_read_b64_tr_b16 a[56:57], v54 offset:49152
    v_mfma_f32_16x16x32_bf16 v[204:207], a[20:23], a[68:71], v[204:207]
    buffer_load_dwordx4 v5, s[52:55], s33 offen offset:1024  lds
    v_mfma_f32_16x16x32_bf16 v[196:199], a[20:23], a[64:67], v[196:199]
    ds_read_b64_tr_b16 a[58:59], v54 offset:53248
    v_mfma_f32_16x16x32_bf16 v[224:227], a[24:27], a[64:67], v[224:227]
    ds_read_b64_tr_b16 a[60:61], v55 offset:49152
    v_mfma_f32_16x16x32_bf16 v[232:235], a[24:27], a[68:71], v[232:235]
    ds_read_b64_tr_b16 a[62:63], v55 offset:53248
    v_mfma_f32_16x16x32_bf16 v[240:243], a[24:27], a[72:75], v[240:243]
    buffer_load_dwordx4 v6, s[52:55], s33 offen offset:2048  lds
    v_mfma_f32_16x16x32_bf16 v[248:251], a[24:27], a[76:79], v[248:251]
    v_mfma_f32_16x16x32_bf16 v[252:255], a[28:31], a[76:79], v[252:255]
    v_mfma_f32_16x16x32_bf16 v[244:247], a[28:31], a[72:75], v[244:247]
    v_mfma_f32_16x16x32_bf16 v[236:239], a[28:31], a[68:71], v[236:239]
    buffer_load_dwordx4 v7, s[52:55], s33 offen offset:3072  lds
    v_mfma_f32_16x16x32_bf16 v[228:231], a[28:31], a[64:67], v[228:231]
    s_waitcnt vmcnt(12) lgkmcnt(0)
    s_barrier
    v_mfma_f32_16x16x32_bf16 v[128:131], a[32:35], a[80:83], v[128:131]
    ds_read_b128 a[64:67], v28 offset:32768
    s_add_u32 m0, s36, 49152
    v_mfma_f32_16x16x32_bf16 v[136:139], a[32:35], a[84:87], v[136:139]
    ds_read_b128 a[68:71], v28 offset:34816
    s_xor_b32 s33, s30, 2883584
    v_mfma_f32_16x16x32_bf16 v[144:147], a[32:35], a[88:91], v[144:147]
    buffer_load_dwordx4 v4, s[52:55], s33 offen offset:0  lds
    v_mfma_f32_16x16x32_bf16 v[152:155], a[32:35], a[92:95], v[152:155]
    ds_read_b128 a[72:75], v28 offset:36864
    v_mfma_f32_16x16x32_bf16 v[156:159], a[36:39], a[92:95], v[156:159]
    ds_read_b128 a[76:79], v28 offset:38912
    v_mfma_f32_16x16x32_bf16 v[148:151], a[36:39], a[88:91], v[148:151]
    ds_read_b64_tr_b16 a[0:1], v48 offset:0
    v_mfma_f32_16x16x32_bf16 v[140:143], a[36:39], a[84:87], v[140:143]
    buffer_load_dwordx4 v5, s[52:55], s33 offen offset:1024  lds
    v_mfma_f32_16x16x32_bf16 v[132:135], a[36:39], a[80:83], v[132:135]
    ds_read_b64_tr_b16 a[2:3], v48 offset:4096
    v_mfma_f32_16x16x32_bf16 v[160:163], a[40:43], a[80:83], v[160:163]
    ds_read_b64_tr_b16 a[4:5], v49 offset:0
    v_mfma_f32_16x16x32_bf16 v[168:171], a[40:43], a[84:87], v[168:171]
    ds_read_b64_tr_b16 a[6:7], v49 offset:4096
    v_mfma_f32_16x16x32_bf16 v[176:179], a[40:43], a[88:91], v[176:179]
    buffer_load_dwordx4 v6, s[52:55], s33 offen offset:2048  lds
    v_mfma_f32_16x16x32_bf16 v[184:187], a[40:43], a[92:95], v[184:187]
    ds_read_b64_tr_b16 a[8:9], v50 offset:0
    v_mfma_f32_16x16x32_bf16 v[188:191], a[44:47], a[92:95], v[188:191]
    ds_read_b64_tr_b16 a[10:11], v50 offset:4096
    v_mfma_f32_16x16x32_bf16 v[180:183], a[44:47], a[88:91], v[180:183]
    ds_read_b64_tr_b16 a[12:13], v51 offset:0
    v_mfma_f32_16x16x32_bf16 v[172:175], a[44:47], a[84:87], v[172:175]
    buffer_load_dwordx4 v7, s[52:55], s33 offen offset:3072  lds
    s_add_u32 m0, s38, 98304
    v_mfma_f32_16x16x32_bf16 v[164:167], a[44:47], a[80:83], v[164:167]
    ds_read_b64_tr_b16 a[14:15], v51 offset:4096
    s_xor_b32 s33, s31, 524288
    v_mfma_f32_16x16x32_bf16 v[192:195], a[48:51], a[80:83], v[192:195]
    ds_read_b64_tr_b16 a[16:17], v52 offset:0
    v_mfma_f32_16x16x32_bf16 v[200:203], a[48:51], a[84:87], v[200:203]
    ds_read_b64_tr_b16 a[18:19], v52 offset:4096
    v_mfma_f32_16x16x32_bf16 v[208:211], a[48:51], a[88:91], v[208:211]
    buffer_load_dwordx4 v24, s[44:47], s33 offen offset:0 nt lds
    v_mfma_f32_16x16x32_bf16 v[216:219], a[48:51], a[92:95], v[216:219]
    ds_read_b64_tr_b16 a[20:21], v53 offset:0
    v_mfma_f32_16x16x32_bf16 v[220:223], a[52:55], a[92:95], v[220:223]
    ds_read_b64_tr_b16 a[22:23], v53 offset:4096
    v_mfma_f32_16x16x32_bf16 v[212:215], a[52:55], a[88:91], v[212:215]
    ds_read_b64_tr_b16 a[24:25], v54 offset:0
    v_mfma_f32_16x16x32_bf16 v[204:207], a[52:55], a[84:87], v[204:207]
    buffer_load_dwordx4 v25, s[44:47], s33 offen offset:1024 nt lds
    v_mfma_f32_16x16x32_bf16 v[196:199], a[52:55], a[80:83], v[196:199]
    ds_read_b64_tr_b16 a[26:27], v54 offset:4096
    v_mfma_f32_16x16x32_bf16 v[224:227], a[56:59], a[80:83], v[224:227]
    ds_read_b64_tr_b16 a[28:29], v55 offset:0
    v_mfma_f32_16x16x32_bf16 v[232:235], a[56:59], a[84:87], v[232:235]
    ds_read_b64_tr_b16 a[30:31], v55 offset:4096
    v_mfma_f32_16x16x32_bf16 v[240:243], a[56:59], a[88:91], v[240:243]
    buffer_load_dwordx4 v26, s[44:47], s33 offen offset:2048 nt lds
    v_mfma_f32_16x16x32_bf16 v[248:251], a[56:59], a[92:95], v[248:251]
    v_mfma_f32_16x16x32_bf16 v[252:255], a[60:63], a[92:95], v[252:255]
    v_mfma_f32_16x16x32_bf16 v[244:247], a[60:63], a[88:91], v[244:247]
    v_mfma_f32_16x16x32_bf16 v[236:239], a[60:63], a[84:87], v[236:239]
    buffer_load_dwordx4 v27, s[44:47], s33 offen offset:3072 nt lds
    v_mfma_f32_16x16x32_bf16 v[228:231], a[60:63], a[80:83], v[228:231]
    s_waitcnt vmcnt(16) lgkmcnt(0)
    s_barrier
    v_mfma_f32_16x16x32_bf16 v[128:131], a[0:3], a[64:67], v[128:131]
    ds_read_b128 a[80:83], v29 offset:32768
    s_add_u32 m0, s38, 102400
    v_mfma_f32_16x16x32_bf16 v[136:139], a[0:3], a[68:71], v[136:139]
    ds_read_b128 a[84:87], v29 offset:34816
    s_xor_b32 s33, s31, 528384
    v_mfma_f32_16x16x32_bf16 v[144:147], a[0:3], a[72:75], v[144:147]
    buffer_load_dwordx4 v24, s[44:47], s33 offen offset:0 nt lds
    v_mfma_f32_16x16x32_bf16 v[152:155], a[0:3], a[76:79], v[152:155]
    ds_read_b128 a[88:91], v29 offset:36864
    v_mfma_f32_16x16x32_bf16 v[156:159], a[4:7], a[76:79], v[156:159]
    ds_read_b128 a[92:95], v29 offset:38912
    v_mfma_f32_16x16x32_bf16 v[148:151], a[4:7], a[72:75], v[148:151]
    ds_read_b64_tr_b16 a[32:33], v48 offset:16384
    v_mfma_f32_16x16x32_bf16 v[140:143], a[4:7], a[68:71], v[140:143]
    buffer_load_dwordx4 v25, s[44:47], s33 offen offset:1024 nt lds
    v_mfma_f32_16x16x32_bf16 v[132:135], a[4:7], a[64:67], v[132:135]
    ds_read_b64_tr_b16 a[34:35], v48 offset:20480
    v_mfma_f32_16x16x32_bf16 v[160:163], a[8:11], a[64:67], v[160:163]
    ds_read_b64_tr_b16 a[36:37], v49 offset:16384
    v_mfma_f32_16x16x32_bf16 v[168:171], a[8:11], a[68:71], v[168:171]
    ds_read_b64_tr_b16 a[38:39], v49 offset:20480
    v_mfma_f32_16x16x32_bf16 v[176:179], a[8:11], a[72:75], v[176:179]
    buffer_load_dwordx4 v26, s[44:47], s33 offen offset:2048 nt lds
    v_mfma_f32_16x16x32_bf16 v[184:187], a[8:11], a[76:79], v[184:187]
    ds_read_b64_tr_b16 a[40:41], v50 offset:16384
    v_mfma_f32_16x16x32_bf16 v[188:191], a[12:15], a[76:79], v[188:191]
    ds_read_b64_tr_b16 a[42:43], v50 offset:20480
    v_mfma_f32_16x16x32_bf16 v[180:183], a[12:15], a[72:75], v[180:183]
    ds_read_b64_tr_b16 a[44:45], v51 offset:16384
    v_mfma_f32_16x16x32_bf16 v[172:175], a[12:15], a[68:71], v[172:175]
    buffer_load_dwordx4 v27, s[44:47], s33 offen offset:3072 nt lds
    v_mfma_f32_16x16x32_bf16 v[164:167], a[12:15], a[64:67], v[164:167]
    ds_read_b64_tr_b16 a[46:47], v51 offset:20480
    v_mfma_f32_16x16x32_bf16 v[192:195], a[16:19], a[64:67], v[192:195]
    ds_read_b64_tr_b16 a[48:49], v52 offset:16384
    v_mfma_f32_16x16x32_bf16 v[200:203], a[16:19], a[68:71], v[200:203]
    ds_read_b64_tr_b16 a[50:51], v52 offset:20480
    v_mfma_f32_16x16x32_bf16 v[208:211], a[16:19], a[72:75], v[208:211]
    ds_read_b64_tr_b16 a[52:53], v53 offset:16384
    v_mfma_f32_16x16x32_bf16 v[216:219], a[16:19], a[76:79], v[216:219]
    ds_read_b64_tr_b16 a[54:55], v53 offset:20480
    v_mfma_f32_16x16x32_bf16 v[220:223], a[20:23], a[76:79], v[220:223]
    ds_read_b64_tr_b16 a[56:57], v54 offset:16384
    v_mfma_f32_16x16x32_bf16 v[212:215], a[20:23], a[72:75], v[212:215]
    ds_read_b64_tr_b16 a[58:59], v54 offset:20480
    v_mfma_f32_16x16x32_bf16 v[204:207], a[20:23], a[68:71], v[204:207]
    ds_read_b64_tr_b16 a[60:61], v55 offset:16384
    v_mfma_f32_16x16x32_bf16 v[196:199], a[20:23], a[64:67], v[196:199]
    ds_read_b64_tr_b16 a[62:63], v55 offset:20480
    v_mfma_f32_16x16x32_bf16 v[224:227], a[24:27], a[64:67], v[224:227]
    v_mfma_f32_16x16x32_bf16 v[232:235], a[24:27], a[68:71], v[232:235]
    v_mfma_f32_16x16x32_bf16 v[240:243], a[24:27], a[72:75], v[240:243]
    v_mfma_f32_16x16x32_bf16 v[248:251], a[24:27], a[76:79], v[248:251]
    v_mfma_f32_16x16x32_bf16 v[252:255], a[28:31], a[76:79], v[252:255]
    v_mfma_f32_16x16x32_bf16 v[244:247], a[28:31], a[72:75], v[244:247]
    v_mfma_f32_16x16x32_bf16 v[236:239], a[28:31], a[68:71], v[236:239]
    v_mfma_f32_16x16x32_bf16 v[228:231], a[28:31], a[64:67], v[228:231]
    s_waitcnt vmcnt(12) lgkmcnt(0)
    s_barrier
    v_mfma_f32_16x16x32_bf16 v[128:131], a[32:35], a[80:83], v[128:131]
    ds_read_b128 a[64:67], v28 offset:49152
    s_add_u32 m0, s38, 65536
    v_mfma_f32_16x16x32_bf16 v[136:139], a[32:35], a[84:87], v[136:139]
    ds_read_b128 a[68:71], v28 offset:51200
    s_xor_b32 s33, s26, 0
    v_mfma_f32_16x16x32_bf16 v[144:147], a[32:35], a[88:91], v[144:147]
    buffer_load_dwordx4 v12, s[48:51], s33 offen offset:0  lds
    v_mfma_f32_16x16x32_bf16 v[152:155], a[32:35], a[92:95], v[152:155]
    ds_read_b128 a[72:75], v28 offset:53248
    v_mfma_f32_16x16x32_bf16 v[156:159], a[36:39], a[92:95], v[156:159]
    ds_read_b128 a[76:79], v28 offset:55296
    v_mfma_f32_16x16x32_bf16 v[148:151], a[36:39], a[88:91], v[148:151]
    ds_read_b64_tr_b16 a[0:1], v48 offset:32768
    v_mfma_f32_16x16x32_bf16 v[140:143], a[36:39], a[84:87], v[140:143]
    buffer_load_dwordx4 v13, s[48:51], s33 offen offset:1024  lds
    v_mfma_f32_16x16x32_bf16 v[132:135], a[36:39], a[80:83], v[132:135]
    ds_read_b64_tr_b16 a[2:3], v48 offset:36864
    v_mfma_f32_16x16x32_bf16 v[160:163], a[40:43], a[80:83], v[160:163]
    ds_read_b64_tr_b16 a[4:5], v49 offset:32768
    v_mfma_f32_16x16x32_bf16 v[168:171], a[40:43], a[84:87], v[168:171]
    ds_read_b64_tr_b16 a[6:7], v49 offset:36864
    v_mfma_f32_16x16x32_bf16 v[176:179], a[40:43], a[88:91], v[176:179]
    buffer_load_dwordx4 v12, s[48:51], s33 offen offset:2048  lds
    v_mfma_f32_16x16x32_bf16 v[184:187], a[40:43], a[92:95], v[184:187]
    ds_read_b64_tr_b16 a[8:9], v50 offset:32768
    v_mfma_f32_16x16x32_bf16 v[188:191], a[44:47], a[92:95], v[188:191]
    ds_read_b64_tr_b16 a[10:11], v50 offset:36864
    v_mfma_f32_16x16x32_bf16 v[180:183], a[44:47], a[88:91], v[180:183]
    ds_read_b64_tr_b16 a[12:13], v51 offset:32768
    v_mfma_f32_16x16x32_bf16 v[172:175], a[44:47], a[84:87], v[172:175]
    buffer_load_dwordx4 v13, s[48:51], s33 offen offset:3072  lds
    s_add_u32 m0, s38, 69632
    v_mfma_f32_16x16x32_bf16 v[164:167], a[44:47], a[80:83], v[164:167]
    ds_read_b64_tr_b16 a[14:15], v51 offset:36864
    s_xor_b32 s33, s26, 4096
    v_mfma_f32_16x16x32_bf16 v[192:195], a[48:51], a[80:83], v[192:195]
    ds_read_b64_tr_b16 a[16:17], v52 offset:32768
    v_mfma_f32_16x16x32_bf16 v[200:203], a[48:51], a[84:87], v[200:203]
    ds_read_b64_tr_b16 a[18:19], v52 offset:36864
    v_mfma_f32_16x16x32_bf16 v[208:211], a[48:51], a[88:91], v[208:211]
    buffer_load_dwordx4 v12, s[48:51], s33 offen offset:0  lds
    v_mfma_f32_16x16x32_bf16 v[216:219], a[48:51], a[92:95], v[216:219]
    ds_read_b64_tr_b16 a[20:21], v53 offset:32768
    v_mfma_f32_16x16x32_bf16 v[220:223], a[52:55], a[92:95], v[220:223]
    ds_read_b64_tr_b16 a[22:23], v53 offset:36864
    v_mfma_f32_16x16x32_bf16 v[212:215], a[52:55], a[88:91], v[212:215]
    ds_read_b64_tr_b16 a[24:25], v54 offset:32768
    v_mfma_f32_16x16x32_bf16 v[204:207], a[52:55], a[84:87], v[204:207]
    buffer_load_dwordx4 v13, s[48:51], s33 offen offset:1024  lds
    v_mfma_f32_16x16x32_bf16 v[196:199], a[52:55], a[80:83], v[196:199]
    ds_read_b64_tr_b16 a[26:27], v54 offset:36864
    v_mfma_f32_16x16x32_bf16 v[224:227], a[56:59], a[80:83], v[224:227]
    ds_read_b64_tr_b16 a[28:29], v55 offset:32768
    v_mfma_f32_16x16x32_bf16 v[232:235], a[56:59], a[84:87], v[232:235]
    ds_read_b64_tr_b16 a[30:31], v55 offset:36864
    v_mfma_f32_16x16x32_bf16 v[240:243], a[56:59], a[88:91], v[240:243]
    buffer_load_dwordx4 v12, s[48:51], s33 offen offset:2048  lds
    v_mfma_f32_16x16x32_bf16 v[248:251], a[56:59], a[92:95], v[248:251]
    v_mfma_f32_16x16x32_bf16 v[252:255], a[60:63], a[92:95], v[252:255]
    v_mfma_f32_16x16x32_bf16 v[244:247], a[60:63], a[88:91], v[244:247]
    v_mfma_f32_16x16x32_bf16 v[236:239], a[60:63], a[84:87], v[236:239]
    buffer_load_dwordx4 v13, s[48:51], s33 offen offset:3072  lds
    v_mfma_f32_16x16x32_bf16 v[228:231], a[60:63], a[80:83], v[228:231]
    s_waitcnt vmcnt(16) lgkmcnt(0)
    s_barrier
    v_mfma_f32_16x16x32_bf16 v[128:131], a[0:3], a[64:67], v[128:131]
    ds_read_b128 a[80:83], v29 offset:49152
    v_mfma_f32_16x16x32_bf16 v[136:139], a[0:3], a[68:71], v[136:139]
    ds_read_b128 a[84:87], v29 offset:51200
    v_mfma_f32_16x16x32_bf16 v[144:147], a[0:3], a[72:75], v[144:147]
    ds_read_b128 a[88:91], v29 offset:53248
    v_mfma_f32_16x16x32_bf16 v[152:155], a[0:3], a[76:79], v[152:155]
    ds_read_b128 a[92:95], v29 offset:55296
    v_mfma_f32_16x16x32_bf16 v[156:159], a[4:7], a[76:79], v[156:159]
    ds_read_b64_tr_b16 a[32:33], v48 offset:49152
    v_mfma_f32_16x16x32_bf16 v[148:151], a[4:7], a[72:75], v[148:151]
    ds_read_b64_tr_b16 a[34:35], v48 offset:53248
    v_mfma_f32_16x16x32_bf16 v[140:143], a[4:7], a[68:71], v[140:143]
    ds_read_b64_tr_b16 a[36:37], v49 offset:49152
    v_mfma_f32_16x16x32_bf16 v[132:135], a[4:7], a[64:67], v[132:135]
    ds_read_b64_tr_b16 a[38:39], v49 offset:53248
    v_mfma_f32_16x16x32_bf16 v[160:163], a[8:11], a[64:67], v[160:163]
    ds_read_b64_tr_b16 a[40:41], v50 offset:49152
    v_mfma_f32_16x16x32_bf16 v[168:171], a[8:11], a[68:71], v[168:171]
    ds_read_b64_tr_b16 a[42:43], v50 offset:53248
    v_mfma_f32_16x16x32_bf16 v[176:179], a[8:11], a[72:75], v[176:179]
    ds_read_b64_tr_b16 a[44:45], v51 offset:49152
    v_mfma_f32_16x16x32_bf16 v[184:187], a[8:11], a[76:79], v[184:187]
    ds_read_b64_tr_b16 a[46:47], v51 offset:53248
    v_mfma_f32_16x16x32_bf16 v[188:191], a[12:15], a[76:79], v[188:191]
    ds_read_b64_tr_b16 a[48:49], v52 offset:49152
    v_mfma_f32_16x16x32_bf16 v[180:183], a[12:15], a[72:75], v[180:183]
    ds_read_b64_tr_b16 a[50:51], v52 offset:53248
    v_mfma_f32_16x16x32_bf16 v[172:175], a[12:15], a[68:71], v[172:175]
    ds_read_b64_tr_b16 a[52:53], v53 offset:49152
    v_mfma_f32_16x16x32_bf16 v[164:167], a[12:15], a[64:67], v[164:167]
    ds_read_b64_tr_b16 a[54:55], v53 offset:53248
    v_mfma_f32_16x16x32_bf16 v[192:195], a[16:19], a[64:67], v[192:195]
    ds_read_b64_tr_b16 a[56:57], v54 offset:49152
    v_mfma_f32_16x16x32_bf16 v[200:203], a[16:19], a[68:71], v[200:203]
    ds_read_b64_tr_b16 a[58:59], v54 offset:53248
    v_mfma_f32_16x16x32_bf16 v[208:211], a[16:19], a[72:75], v[208:211]
    ds_read_b64_tr_b16 a[60:61], v55 offset:49152
    v_mfma_f32_16x16x32_bf16 v[216:219], a[16:19], a[76:79], v[216:219]
    ds_read_b64_tr_b16 a[62:63], v55 offset:53248
    v_mfma_f32_16x16x32_bf16 v[220:223], a[20:23], a[76:79], v[220:223]
    v_mfma_f32_16x16x32_bf16 v[212:215], a[20:23], a[72:75], v[212:215]
    v_mfma_f32_16x16x32_bf16 v[204:207], a[20:23], a[68:71], v[204:207]
    v_mfma_f32_16x16x32_bf16 v[196:199], a[20:23], a[64:67], v[196:199]
    v_mfma_f32_16x16x32_bf16 v[224:227], a[24:27], a[64:67], v[224:227]
    v_mfma_f32_16x16x32_bf16 v[232:235], a[24:27], a[68:71], v[232:235]
    v_mfma_f32_16x16x32_bf16 v[240:243], a[24:27], a[72:75], v[240:243]
    v_mfma_f32_16x16x32_bf16 v[248:251], a[24:27], a[76:79], v[248:251]
    v_mfma_f32_16x16x32_bf16 v[252:255], a[28:31], a[76:79], v[252:255]
    v_mfma_f32_16x16x32_bf16 v[244:247], a[28:31], a[72:75], v[244:247]
    v_mfma_f32_16x16x32_bf16 v[236:239], a[28:31], a[68:71], v[236:239]
    v_mfma_f32_16x16x32_bf16 v[228:231], a[28:31], a[64:67], v[228:231]
    s_waitcnt vmcnt(8) lgkmcnt(0)
    s_barrier
    v_mfma_f32_16x16x32_bf16 v[128:131], a[32:35], a[80:83], v[128:131]
    ds_read_b64 a[160:161], v32 offset:32768
    s_add_u32 m0, s37, 0
    v_mfma_f32_16x16x32_bf16 v[136:139], a[32:35], a[84:87], v[136:139]
    ds_read_b64 a[176:177], v32 offset:36864
    s_xor_b32 s33, s32, 128
    v_mfma_f32_16x16x32_bf16 v[140:143], a[36:39], a[84:87], v[140:143]
    buffer_load_dwordx4 v8, s[56:59], s33 offen offset:0  lds
    v_add_u32 v4, 98304, v0
    v_mfma_f32_16x16x32_bf16 v[132:135], a[36:39], a[80:83], v[132:135]
    ds_read_b64 a[162:163], v33 offset:32768
    v_mfma_f32_16x16x32_bf16 v[160:163], a[40:43], a[80:83], v[160:163]
    ds_read_b64 a[178:179], v33 offset:36864
    v_add_u32 v5, 98304, v1
    v_mfma_f32_16x16x32_bf16 v[168:171], a[40:43], a[84:87], v[168:171]
    ds_read_b64 a[164:165], v34 offset:32768
    v_mfma_f32_16x16x32_bf16 v[172:175], a[44:47], a[84:87], v[172:175]
    buffer_load_dwordx4 v9, s[56:59], s33 offen offset:1024  lds
    v_add_u32 v6, 98304, v2
    v_mfma_f32_16x16x32_bf16 v[164:167], a[44:47], a[80:83], v[164:167]
    ds_read_b64 a[180:181], v34 offset:36864
    v_mfma_f32_16x16x32_bf16 v[192:195], a[48:51], a[80:83], v[192:195]
    ds_read_b64 a[166:167], v35 offset:32768
    v_add_u32 v7, 98304, v3
    v_mfma_f32_16x16x32_bf16 v[200:203], a[48:51], a[84:87], v[200:203]
    ds_read_b64 a[182:183], v35 offset:36864
    v_mfma_f32_16x16x32_bf16 v[204:207], a[52:55], a[84:87], v[204:207]
    buffer_load_dwordx4 v10, s[56:59], s33 offen offset:2048  lds
    v_mfma_f32_16x16x32_bf16 v[196:199], a[52:55], a[80:83], v[196:199]
    ds_read_b64 a[168:169], v36 offset:32768
    v_mfma_f32_16x16x32_bf16 v[224:227], a[56:59], a[80:83], v[224:227]
    ds_read_b64 a[184:185], v36 offset:36864
    v_mfma_f32_16x16x32_bf16 v[232:235], a[56:59], a[84:87], v[232:235]
    ds_read_b64 a[170:171], v37 offset:32768
    v_mfma_f32_16x16x32_bf16 v[236:239], a[60:63], a[84:87], v[236:239]
    buffer_load_dwordx4 v11, s[56:59], s33 offen offset:3072  lds
    v_mfma_f32_16x16x32_bf16 v[228:231], a[60:63], a[80:83], v[228:231]
    ds_read_b64 a[186:187], v37 offset:36864
    v_mfma_f32_16x16x32_bf16 v[144:147], a[32:35], a[88:91], v[144:147]
    ds_read_b64 a[172:173], v38 offset:32768
    v_mfma_f32_16x16x32_bf16 v[152:155], a[32:35], a[92:95], v[152:155]
    ds_read_b64 a[188:189], v38 offset:36864
    v_mfma_f32_16x16x32_bf16 v[156:159], a[36:39], a[92:95], v[156:159]
    ds_read_b64 a[174:175], v39 offset:32768
    v_mfma_f32_16x16x32_bf16 v[148:151], a[36:39], a[88:91], v[148:151]
    ds_read_b64 a[190:191], v39 offset:36864
    v_mfma_f32_16x16x32_bf16 v[176:179], a[40:43], a[88:91], v[176:179]
    v_cvt_pk_bf16_f32 v64, v128, v129
    v_cvt_pk_bf16_f32 v65, v130, v131
    v_mfma_f32_16x16x32_bf16 v[184:187], a[40:43], a[92:95], v[184:187]
    v_cvt_pk_bf16_f32 v66, v132, v133
    v_cvt_pk_bf16_f32 v67, v134, v135
    v_mfma_f32_16x16x32_bf16 v[188:191], a[44:47], a[92:95], v[188:191]
    v_cvt_pk_bf16_f32 v80, v136, v137
    v_cvt_pk_bf16_f32 v81, v138, v139
    v_mfma_f32_16x16x32_bf16 v[180:183], a[44:47], a[88:91], v[180:183]
    v_cvt_pk_bf16_f32 v82, v140, v141
    v_cvt_pk_bf16_f32 v83, v142, v143
    v_mfma_f32_16x16x32_bf16 v[208:211], a[48:51], a[88:91], v[208:211]
    v_cvt_pk_bf16_f32 v68, v160, v161
    v_cvt_pk_bf16_f32 v69, v162, v163
    v_mfma_f32_16x16x32_bf16 v[216:219], a[48:51], a[92:95], v[216:219]
    v_cvt_pk_bf16_f32 v70, v164, v165
    v_cvt_pk_bf16_f32 v71, v166, v167
    v_mfma_f32_16x16x32_bf16 v[220:223], a[52:55], a[92:95], v[220:223]
    v_cvt_pk_bf16_f32 v84, v168, v169
    v_cvt_pk_bf16_f32 v85, v170, v171
    v_mfma_f32_16x16x32_bf16 v[212:215], a[52:55], a[88:91], v[212:215]
    v_cvt_pk_bf16_f32 v86, v172, v173
    v_cvt_pk_bf16_f32 v87, v174, v175
    v_mfma_f32_16x16x32_bf16 v[240:243], a[56:59], a[88:91], v[240:243]
    v_cvt_pk_bf16_f32 v72, v192, v193
    v_cvt_pk_bf16_f32 v73, v194, v195
    v_mfma_f32_16x16x32_bf16 v[248:251], a[56:59], a[92:95], v[248:251]
    v_cvt_pk_bf16_f32 v74, v196, v197
    v_cvt_pk_bf16_f32 v75, v198, v199
    v_mfma_f32_16x16x32_bf16 v[252:255], a[60:63], a[92:95], v[252:255]
    v_cvt_pk_bf16_f32 v88, v200, v201
    v_cvt_pk_bf16_f32 v89, v202, v203
    v_mfma_f32_16x16x32_bf16 v[244:247], a[60:63], a[88:91], v[244:247]
    v_cvt_pk_bf16_f32 v90, v204, v205
    v_cvt_pk_bf16_f32 v91, v206, v207
    s_waitcnt lgkmcnt(0)
    s_load_dword s14, s[6:7], s13
    v_mfma_f32_16x16x32_bf16 v[128:131], a[128:131], v[64:67], 0
    v_cvt_pk_bf16_f32 v76, v224, v225
    v_cvt_pk_bf16_f32 v77, v226, v227
    v_mfma_f32_16x16x32_bf16 v[132:135], a[144:147], v[64:67], 0
    v_cvt_pk_bf16_f32 v78, v228, v229
    v_cvt_pk_bf16_f32 v79, v230, v231
    v_mfma_f32_16x16x32_bf16 v[136:139], a[128:131], v[80:83], 0
    v_cvt_pk_bf16_f32 v92, v232, v233
    v_cvt_pk_bf16_f32 v93, v234, v235
    v_mfma_f32_16x16x32_bf16 v[140:143], a[144:147], v[80:83], 0
    v_cvt_pk_bf16_f32 v94, v236, v237
    v_cvt_pk_bf16_f32 v95, v238, v239
    v_mfma_f32_16x16x32_bf16 v[128:131], a[132:135], v[68:71], v[128:131]
    v_cvt_pk_bf16_f32 v96, v144, v145
    v_cvt_pk_bf16_f32 v97, v146, v147
    v_mfma_f32_16x16x32_bf16 v[132:135], a[148:151], v[68:71], v[132:135]
    v_cvt_pk_bf16_f32 v98, v148, v149
    v_cvt_pk_bf16_f32 v99, v150, v151
    v_mfma_f32_16x16x32_bf16 v[136:139], a[132:135], v[84:87], v[136:139]
    v_cvt_pk_bf16_f32 v112, v152, v153
    v_cvt_pk_bf16_f32 v113, v154, v155
    v_mfma_f32_16x16x32_bf16 v[140:143], a[148:151], v[84:87], v[140:143]
    v_cvt_pk_bf16_f32 v114, v156, v157
    v_cvt_pk_bf16_f32 v115, v158, v159
    v_mfma_f32_16x16x32_bf16 v[128:131], a[136:139], v[72:75], v[128:131]
    v_cvt_pk_bf16_f32 v100, v176, v177
    v_cvt_pk_bf16_f32 v101, v178, v179
    v_mfma_f32_16x16x32_bf16 v[132:135], a[152:155], v[72:75], v[132:135]
    v_cvt_pk_bf16_f32 v102, v180, v181
    v_cvt_pk_bf16_f32 v103, v182, v183
    v_mfma_f32_16x16x32_bf16 v[136:139], a[136:139], v[88:91], v[136:139]
    v_cvt_pk_bf16_f32 v116, v184, v185
    v_cvt_pk_bf16_f32 v117, v186, v187
    v_mfma_f32_16x16x32_bf16 v[140:143], a[152:155], v[88:91], v[140:143]
    v_cvt_pk_bf16_f32 v118, v188, v189
    v_cvt_pk_bf16_f32 v119, v190, v191
    v_mfma_f32_16x16x32_bf16 v[128:131], a[140:143], v[76:79], v[128:131]
    v_cvt_pk_bf16_f32 v104, v208, v209
    v_cvt_pk_bf16_f32 v105, v210, v211
    v_mfma_f32_16x16x32_bf16 v[132:135], a[156:159], v[76:79], v[132:135]
    v_cvt_pk_bf16_f32 v106, v212, v213
    v_cvt_pk_bf16_f32 v107, v214, v215
    v_mfma_f32_16x16x32_bf16 v[136:139], a[140:143], v[92:95], v[136:139]
    v_cvt_pk_bf16_f32 v120, v216, v217
    v_cvt_pk_bf16_f32 v121, v218, v219
    v_mfma_f32_16x16x32_bf16 v[140:143], a[156:159], v[92:95], v[140:143]
    v_cvt_pk_bf16_f32 v122, v220, v221
    v_cvt_pk_bf16_f32 v123, v222, v223
    v_mfma_f32_16x16x32_bf16 v[160:163], a[160:163], v[96:99], 0
    v_cvt_pk_bf16_f32 v108, v240, v241
    v_cvt_pk_bf16_f32 v109, v242, v243
    v_mfma_f32_16x16x32_bf16 v[164:167], a[176:179], v[96:99], 0
    s_add_u32 m0, s37, 16384
    s_xor_b32 s33, s32, 256
    v_mfma_f32_16x16x32_bf16 v[168:171], a[160:163], v[112:115], 0
    buffer_load_dwordx4 v8, s[56:59], s33 offen offset:0  lds
    v_cvt_pk_bf16_f32 v110, v244, v245
    v_cvt_pk_bf16_f32 v111, v246, v247
    v_mfma_f32_16x16x32_bf16 v[172:175], a[176:179], v[112:115], 0
    v_cvt_pk_bf16_f32 v124, v248, v249
    v_cvt_pk_bf16_f32 v125, v250, v251
    v_mfma_f32_16x16x32_bf16 v[160:163], a[164:167], v[100:103], v[160:163]
    buffer_load_dwordx4 v9, s[56:59], s33 offen offset:1024  lds
    v_cvt_pk_bf16_f32 v126, v252, v253
    v_cvt_pk_bf16_f32 v127, v254, v255
    v_mfma_f32_16x16x32_bf16 v[164:167], a[180:183], v[100:103], v[164:167]
    v_max3_f32 v40, v128, v129, v130
    v_max3_f32 v41, v136, v137, v138
    v_mfma_f32_16x16x32_bf16 v[168:171], a[164:167], v[116:119], v[168:171]
    buffer_load_dwordx4 v10, s[56:59], s33 offen offset:2048  lds
    v_max3_f32 v40, v40, v131, v132
    v_max3_f32 v41, v41, v139, v140
    v_mfma_f32_16x16x32_bf16 v[172:175], a[180:183], v[116:119], v[172:175]
    v_max3_f32 v40, v40, v133, v134
    v_max3_f32 v41, v41, v141, v142
    v_mfma_f32_16x16x32_bf16 v[160:163], a[168:171], v[104:107], v[160:163]
    buffer_load_dwordx4 v11, s[56:59], s33 offen offset:3072  lds
    v_max_f32 v40, v40, v135
    v_mfma_f32_16x16x32_bf16 v[164:167], a[184:187], v[104:107], v[164:167]
    v_max_f32 v41, v41, v143
    s_nop 0
    v_mfma_f32_16x16x32_bf16 v[168:171], a[168:171], v[120:123], v[168:171]
    v_permlane32_swap_b32 v40, v41
    v_mfma_f32_16x16x32_bf16 v[172:175], a[184:187], v[120:123], v[172:175]
    v_max_f32 v40, v40, v41
    v_mov_b32 v41, v40
    v_mfma_f32_16x16x32_bf16 v[160:163], a[172:175], v[108:111], v[160:163]
    s_nop 0
    v_mfma_f32_16x16x32_bf16 v[164:167], a[188:191], v[108:111], v[164:167]
    v_permlane16_swap_b32 v40, v41
    v_max_f32 v40, v40, v41
    v_mfma_f32_16x16x32_bf16 v[168:171], a[172:175], v[124:127], v[168:171]
    v_mul_f32 v40, s35, v40
    v_mov_b32 v41, v40
    v_mfma_f32_16x16x32_bf16 v[172:175], a[188:191], v[124:127], v[172:175]
    s_nop 0
    v_permlane32_swap_b32 v40, v41
    s_xor_b32 s39, s16, 131072
    v_pk_fma_f32 v[128:129], v[128:129], s[34:35], v[40:41] op_sel:[0,0,0] op_sel_hi:[1,0,0]
    v_pk_fma_f32 v[130:131], v[130:131], s[34:35], v[40:41] op_sel:[0,0,0] op_sel_hi:[1,0,0]
    v_pk_fma_f32 v[132:133], v[132:133], s[34:35], v[40:41] op_sel:[0,0,0] op_sel_hi:[1,0,0]
    v_pk_fma_f32 v[134:135], v[134:135], s[34:35], v[40:41] op_sel:[0,0,0] op_sel_hi:[1,0,0]
    v_pk_fma_f32 v[136:137], v[136:137], s[34:35], v[40:41] op_sel:[0,0,1] op_sel_hi:[1,0,1]
    v_pk_fma_f32 v[138:139], v[138:139], s[34:35], v[40:41] op_sel:[0,0,1] op_sel_hi:[1,0,1]
    v_pk_fma_f32 v[140:141], v[140:141], s[34:35], v[40:41] op_sel:[0,0,1] op_sel_hi:[1,0,1]
    v_pk_fma_f32 v[142:143], v[142:143], s[34:35], v[40:41] op_sel:[0,0,1] op_sel_hi:[1,0,1]
    v_max3_f32 v42, v160, v161, v162
    v_max3_f32 v43, v168, v169, v170
    v_max3_f32 v42, v42, v163, v164
    v_max3_f32 v43, v43, v171, v172
    v_max3_f32 v42, v42, v165, v166
    v_max3_f32 v43, v43, v173, v174
    v_max_f32 v42, v42, v167
    v_max_f32 v43, v43, v175
    s_add_u32 m0, s37, 32768
    s_xor_b32 s33, s32, 384
    v_exp_f32 v128, v128
    v_exp_f32 v129, v129
    v_permlane32_swap_b32 v42, v43
    v_max_f32 v42, v42, v43
    v_mov_b32 v43, v42
    v_exp_f32 v130, v130
    v_exp_f32 v131, v131
    v_permlane16_swap_b32 v42, v43
    v_max_f32 v42, v42, v43
    v_mul_f32 v42, s35, v42
    v_mov_b32 v43, v42
    v_exp_f32 v132, v132
    v_exp_f32 v133, v133
    v_permlane32_swap_b32 v42, v43
    v_exp_f32 v134, v134
    v_exp_f32 v135, v135
    buffer_load_dwordx4 v8, s[56:59], s33 offen offset:0  lds
    v_exp_f32 v136, v136
    v_exp_f32 v137, v137
    v_exp_f32 v138, v138
    v_exp_f32 v139, v139
    v_exp_f32 v140, v140
    v_exp_f32 v141, v141
    v_exp_f32 v142, v142
    v_exp_f32 v143, v143
    v_pk_fma_f32 v[160:161], v[160:161], s[34:35], v[42:43] op_sel:[0,0,0] op_sel_hi:[1,0,0]
    v_pk_fma_f32 v[162:163], v[162:163], s[34:35], v[42:43] op_sel:[0,0,0] op_sel_hi:[1,0,0]
    v_pk_fma_f32 v[164:165], v[164:165], s[34:35], v[42:43] op_sel:[0,0,0] op_sel_hi:[1,0,0]
    v_pk_fma_f32 v[166:167], v[166:167], s[34:35], v[42:43] op_sel:[0,0,0] op_sel_hi:[1,0,0]
    v_pk_fma_f32 v[168:169], v[168:169], s[34:35], v[42:43] op_sel:[0,0,1] op_sel_hi:[1,0,1]
    v_pk_fma_f32 v[170:171], v[170:171], s[34:35], v[42:43] op_sel:[0,0,1] op_sel_hi:[1,0,1]
    v_pk_fma_f32 v[172:173], v[172:173], s[34:35], v[42:43] op_sel:[0,0,1] op_sel_hi:[1,0,1]
    v_pk_fma_f32 v[174:175], v[174:175], s[34:35], v[42:43] op_sel:[0,0,1] op_sel_hi:[1,0,1]
    buffer_load_dwordx4 v9, s[56:59], s33 offen offset:1024  lds
    v_pk_add_f32 v[48:49], v[128:129], v[130:131]
    v_pk_add_f32 v[52:53], v[136:137], v[138:139]
    v_pk_add_f32 v[50:51], v[132:133], v[134:135]
    v_pk_add_f32 v[54:55], v[140:141], v[142:143]
    v_pk_add_f32 v[48:49], v[48:49], v[50:51]
    v_pk_add_f32 v[52:53], v[52:53], v[54:55]
    v_add_f32 v40, v48, v49
    v_add_f32 v41, v52, v53
    v_exp_f32 v160, v160
    v_exp_f32 v161, v161
    v_permlane32_swap_b32 v40, v41
    v_add_f32 v40, v40, v41
    v_mov_b32 v41, v40
    v_exp_f32 v162, v162
    v_exp_f32 v163, v163
    v_permlane16_swap_b32 v40, v41
    buffer_load_dwordx4 v10, s[56:59], s33 offen offset:2048  lds
    v_add_f32 v40, v40, v41
    v_rcp_f32 v40, v40
    v_exp_f32 v164, v164
    v_mov_b32 v41, v40
    v_exp_f32 v165, v165
    v_exp_f32 v166, v166
    v_permlane32_swap_b32 v40, v41
    v_exp_f32 v167, v167
    v_exp_f32 v168, v168
    v_exp_f32 v169, v169
    v_exp_f32 v170, v170
    v_exp_f32 v171, v171
    v_exp_f32 v172, v172
    v_exp_f32 v173, v173
    v_exp_f32 v174, v174
    v_exp_f32 v175, v175
    buffer_load_dwordx4 v11, s[56:59], s33 offen offset:3072  lds
    v_pk_add_f32 v[56:57], v[160:161], v[162:163]
    v_pk_add_f32 v[60:61], v[168:169], v[170:171]
    v_pk_add_f32 v[58:59], v[164:165], v[166:167]
    v_pk_add_f32 v[62:63], v[172:173], v[174:175]
    v_pk_add_f32 v[56:57], v[56:57], v[58:59]
    v_pk_add_f32 v[60:61], v[60:61], v[62:63]
    v_add_f32 v42, v56, v57
    v_add_f32 v43, v60, v61
    v_pk_mul_f32 v[128:129], v[128:129], v[40:41] op_sel:[0,0] op_sel_hi:[1,0]
    v_pk_mul_f32 v[130:131], v[130:131], v[40:41] op_sel:[0,0] op_sel_hi:[1,0]
    v_permlane32_swap_b32 v42, v43
    v_add_f32 v42, v42, v43
    s_add_u32 m0, s37, 49152
    s_xor_b32 s33, s32, 131200
    v_mov_b32 v43, v42
    v_pk_mul_f32 v[132:133], v[132:133], v[40:41] op_sel:[0,0] op_sel_hi:[1,0]
    v_pk_mul_f32 v[134:135], v[134:135], v[40:41] op_sel:[0,0] op_sel_hi:[1,0]
    v_permlane16_swap_b32 v42, v43
    v_add_f32 v42, v42, v43
    v_rcp_f32 v42, v42
    v_cvt_pk_bf16_f32 v48, v128, v129
    v_mov_b32 v43, v42
    v_cvt_pk_bf16_f32 v49, v130, v131
    v_cvt_pk_bf16_f32 v50, v132, v133
    v_permlane32_swap_b32 v42, v43
    buffer_load_dwordx4 v8, s[56:59], s33 offen offset:0  lds
    v_cvt_pk_bf16_f32 v51, v134, v135
    ds_write_b128 v30, v[48:51] offset:0
    buffer_store_dwordx4 v[48:51], v14, s[60:63], s39 offen offset:0 sc1
    v_pk_mul_f32 v[136:137], v[136:137], v[40:41] op_sel:[0,1] op_sel_hi:[1,1]
    v_pk_mul_f32 v[138:139], v[138:139], v[40:41] op_sel:[0,1] op_sel_hi:[1,1]
    v_pk_mul_f32 v[140:141], v[140:141], v[40:41] op_sel:[0,1] op_sel_hi:[1,1]
    v_pk_mul_f32 v[142:143], v[142:143], v[40:41] op_sel:[0,1] op_sel_hi:[1,1]
    v_cvt_pk_bf16_f32 v52, v136, v137
    v_cvt_pk_bf16_f32 v53, v138, v139
    v_cvt_pk_bf16_f32 v54, v140, v141
    v_cvt_pk_bf16_f32 v55, v142, v143
    buffer_load_dwordx4 v9, s[56:59], s33 offen offset:1024  lds
    ds_write_b128 v30, v[52:55] offset:1024
    buffer_store_dwordx4 v[52:55], v14, s[60:63], s39 offen offset:1024 sc1
    v_pk_mul_f32 v[160:161], v[160:161], v[42:43] op_sel:[0,0] op_sel_hi:[1,0]
    v_pk_mul_f32 v[162:163], v[162:163], v[42:43] op_sel:[0,0] op_sel_hi:[1,0]
    v_pk_mul_f32 v[164:165], v[164:165], v[42:43] op_sel:[0,0] op_sel_hi:[1,0]
    v_pk_mul_f32 v[166:167], v[166:167], v[42:43] op_sel:[0,0] op_sel_hi:[1,0]
    v_cvt_pk_bf16_f32 v56, v160, v161
    v_cvt_pk_bf16_f32 v57, v162, v163
    v_cvt_pk_bf16_f32 v58, v164, v165
    v_cvt_pk_bf16_f32 v59, v166, v167
    ds_write_b128 v30, v[56:59] offset:2048
    buffer_load_dwordx4 v10, s[56:59], s33 offen offset:2048  lds
    buffer_store_dwordx4 v[56:59], v14, s[60:63], s39 offen offset:2048 sc1
    v_pk_mul_f32 v[168:169], v[168:169], v[42:43] op_sel:[0,1] op_sel_hi:[1,1]
    v_pk_mul_f32 v[170:171], v[170:171], v[42:43] op_sel:[0,1] op_sel_hi:[1,1]
    v_pk_mul_f32 v[172:173], v[172:173], v[42:43] op_sel:[0,1] op_sel_hi:[1,1]
    v_pk_mul_f32 v[174:175], v[174:175], v[42:43] op_sel:[0,1] op_sel_hi:[1,1]
    v_cvt_pk_bf16_f32 v60, v168, v169
    v_cvt_pk_bf16_f32 v61, v170, v171
    v_cvt_pk_bf16_f32 v62, v172, v173
    v_cvt_pk_bf16_f32 v63, v174, v175
    ds_write_b128 v30, v[60:63] offset:3072
    buffer_store_dwordx4 v[60:63], v14, s[60:63], s39 offen offset:3072 sc1
    buffer_load_dwordx4 v11, s[56:59], s33 offen offset:3072  lds
    s_waitcnt vmcnt(20)
    ds_read_b64_tr_b16 a[192:193], v16 offset:0
    ds_read_b64_tr_b16 a[194:195], v16 offset:4096
    ds_read_b64_tr_b16 a[196:197], v17 offset:0
    ds_read_b64_tr_b16 a[198:199], v17 offset:4096
    ds_read_b64_tr_b16 a[200:201], v18 offset:0
    ds_read_b64_tr_b16 a[202:203], v18 offset:4096
    ds_read_b64_tr_b16 a[204:205], v19 offset:0
    ds_read_b64_tr_b16 a[206:207], v19 offset:4096
    ds_read_b64_tr_b16 a[208:209], v20 offset:0
    ds_read_b64_tr_b16 a[210:211], v20 offset:4096
    ds_read_b64_tr_b16 a[212:213], v21 offset:0
    ds_read_b64_tr_b16 a[214:215], v21 offset:4096
    ds_read_b64_tr_b16 a[216:217], v22 offset:0
    ds_read_b64_tr_b16 a[218:219], v22 offset:4096
    ds_read_b64_tr_b16 a[220:221], v23 offset:0
    ds_read_b64_tr_b16 a[222:223], v23 offset:4096
L_att:
    s_waitcnt vmcnt(12) lgkmcnt(0)
    s_barrier
    ds_read_b128 a[160:163], v31 offset:0
    ds_read_b128 a[164:167], v31 offset:1024
    ds_read_b128 a[168:171], v31 offset:4096
    ds_read_b128 a[172:175], v31 offset:5120
    ds_read_b64_tr_b16 a[64:65], v2 offset:0
    ds_read_b64_tr_b16 a[66:67], v2 offset:2048
    ds_read_b64_tr_b16 a[80:81], v3 offset:0
    ds_read_b64_tr_b16 a[82:83], v3 offset:2048
    ds_read_b64_tr_b16 a[96:97], v0 offset:0
    ds_read_b64_tr_b16 a[98:99], v0 offset:2048
    ds_read_b64_tr_b16 a[112:113], v1 offset:0
    ds_read_b64_tr_b16 a[114:115], v1 offset:2048
    ds_read_b64_tr_b16 a[68:69], v2 offset:4096
    ds_read_b64_tr_b16 a[70:71], v2 offset:6144
    ds_read_b64_tr_b16 a[84:85], v3 offset:4096
    ds_read_b64_tr_b16 a[86:87], v3 offset:6144
    s_cmp_ge_u32 s14, 1
    s_cbranch_scc0 L_rdy
L_rdy_ok:
    s_mov_b32 s6, 0x200000
    s_mov_b32 s7, 0x20000
    s_mov_b32 s10, 0
    s_waitcnt lgkmcnt(15)
    v_mfma_f32_16x16x32_bf16 v[192:195], a[192:195], a[160:163], 0
    ds_read_b64_tr_b16 a[100:101], v0 offset:4096
    s_add_u32 m0, s38, 65536
    v_mfma_f32_16x16x32_bf16 v[196:199], a[196:199], a[160:163], 0
    ds_read_b64_tr_b16 a[102:103], v0 offset:6144
    s_waitcnt lgkmcnt(15)
    v_mfma_f32_16x16x32_bf16 v[200:203], a[192:195], a[164:167], 0
    ds_read_b64_tr_b16 a[116:117], v1 offset:4096
    ds_read_b64_tr_b16 a[118:119], v1 offset:6144
    v_mfma_f32_16x16x32_bf16 v[204:207], a[196:199], a[164:167], 0
    ds_read_b64_tr_b16 a[72:73], v2 offset:8192
    s_xor_b32 s33, s26, 8192
    v_mfma_f32_16x16x32_bf16 v[208:211], a[200:203], a[160:163], 0
    buffer_load_dwordx4 v12, s[48:51], s33 offen offset:0  lds
    v_cvt_pk_bf16_f32 v128, v192, v193
    v_mfma_f32_16x16x32_bf16 v[212:215], a[204:207], a[160:163], 0
    ds_read_b64_tr_b16 a[74:75], v2 offset:10240
    ds_read_b64_tr_b16 a[88:89], v3 offset:8192
    v_mfma_f32_16x16x32_bf16 v[216:219], a[200:203], a[164:167], 0
    ds_read_b64_tr_b16 a[90:91], v3 offset:10240
    ds_read_b64_tr_b16 a[104:105], v0 offset:8192
    v_mfma_f32_16x16x32_bf16 v[220:223], a[204:207], a[164:167], 0
    ds_read_b64_tr_b16 a[106:107], v0 offset:10240
    v_cvt_pk_bf16_f32 v129, v194, v195
    v_mfma_f32_16x16x32_bf16 v[224:227], a[208:211], a[160:163], 0
    buffer_load_dwordx4 v13, s[48:51], s33 offen offset:1024  lds
    v_cvt_pk_bf16_f32 v130, v196, v197
    v_mfma_f32_16x16x32_bf16 v[228:231], a[212:215], a[160:163], 0
    ds_read_b64_tr_b16 a[120:121], v1 offset:8192
    ds_read_b64_tr_b16 a[122:123], v1 offset:10240
    v_cvt_pk_bf16_f32 v131, v198, v199
    v_mfma_f32_16x16x32_bf16 v[232:235], a[208:211], a[164:167], 0
    ds_read_b64_tr_b16 a[76:77], v2 offset:12288
    ds_read_b64_tr_b16 a[78:79], v2 offset:14336
    v_cvt_pk_bf16_f32 v132, v200, v201
    v_mfma_f32_16x16x32_bf16 v[236:239], a[212:215], a[164:167], 0
    ds_read_b64_tr_b16 a[92:93], v3 offset:12288
    ds_read_b64_tr_b16 a[94:95], v3 offset:14336
    v_cvt_pk_bf16_f32 v133, v202, v203
    v_mfma_f32_16x16x32_bf16 v[240:243], a[216:219], a[160:163], 0
    buffer_load_dwordx4 v12, s[48:51], s33 offen offset:2048  lds
    v_cvt_pk_bf16_f32 v134, v204, v205
    v_mfma_f32_16x16x32_bf16 v[244:247], a[220:223], a[160:163], 0
    ds_read_b64_tr_b16 a[108:109], v0 offset:12288
    ds_read_b64_tr_b16 a[110:111], v0 offset:14336
    v_cvt_pk_bf16_f32 v135, v206, v207
    v_mfma_f32_16x16x32_bf16 v[248:251], a[216:219], a[164:167], 0
    ds_read_b64_tr_b16 a[124:125], v1 offset:12288
    ds_read_b64_tr_b16 a[126:127], v1 offset:14336
    v_cvt_pk_bf16_f32 v136, v208, v209
    v_mfma_f32_16x16x32_bf16 v[252:255], a[220:223], a[164:167], 0
    v_cvt_pk_bf16_f32 v137, v210, v211
    v_cvt_pk_bf16_f32 v138, v212, v213
    buffer_load_dwordx4 v13, s[48:51], s33 offen offset:3072  lds
    v_cvt_pk_bf16_f32 v139, v214, v215
    s_waitcnt lgkmcnt(8)
    v_mfma_f32_16x16x32_bf16 v[80:83], a[64:67], v[128:131], 0
    ds_read_b64_tr_b16 a[0:1], v2 offset:16384
    s_add_u32 m0, s38, 69632
    v_mfma_f32_16x16x32_bf16 v[88:91], a[64:67], v[132:135], 0
    ds_read_b64_tr_b16 a[2:3], v2 offset:18432
    s_xor_b32 s33, s26, 12288
    v_mfma_f32_16x16x32_bf16 v[84:87], a[80:83], v[128:131], 0
    buffer_load_dwordx4 v12, s[48:51], s33 offen offset:0  lds
    v_cvt_pk_bf16_f32 v140, v216, v217
    v_mfma_f32_16x16x32_bf16 v[92:95], a[80:83], v[132:135], 0
    ds_read_b64_tr_b16 a[4:5], v2 offset:20480
    v_cvt_pk_bf16_f32 v141, v218, v219
    v_mfma_f32_16x16x32_bf16 v[64:67], a[96:99], v[128:131], 0
    ds_read_b64_tr_b16 a[6:7], v2 offset:22528
    v_cvt_pk_bf16_f32 v142, v220, v221
    v_mfma_f32_16x16x32_bf16 v[72:75], a[96:99], v[132:135], 0
    ds_read_b64_tr_b16 a[8:9], v2 offset:24576
    v_cvt_pk_bf16_f32 v143, v222, v223
    v_mfma_f32_16x16x32_bf16 v[68:71], a[112:115], v[128:131], 0
    buffer_load_dwordx4 v13, s[48:51], s33 offen offset:1024  lds
    v_cvt_pk_bf16_f32 v144, v224, v225
    v_mfma_f32_16x16x32_bf16 v[76:79], a[112:115], v[132:135], 0
    ds_read_b64_tr_b16 a[10:11], v2 offset:26624
    v_cvt_pk_bf16_f32 v145, v226, v227
    v_mfma_f32_16x16x32_bf16 v[80:83], a[68:71], v[136:139], v[80:83]
    ds_read_b64_tr_b16 a[12:13], v2 offset:28672
    v_cvt_pk_bf16_f32 v146, v228, v229
    v_mfma_f32_16x16x32_bf16 v[88:91], a[68:71], v[140:143], v[88:91]
    ds_read_b64_tr_b16 a[14:15], v2 offset:30720
    v_cvt_pk_bf16_f32 v147, v230, v231
    v_mfma_f32_16x16x32_bf16 v[84:87], a[84:87], v[136:139], v[84:87]
    buffer_load_dwordx4 v12, s[48:51], s33 offen offset:2048  lds
    v_cvt_pk_bf16_f32 v148, v232, v233
    v_mfma_f32_16x16x32_bf16 v[92:95], a[84:87], v[140:143], v[92:95]
    ds_read_b64_tr_b16 a[16:17], v3 offset:16384
    v_cvt_pk_bf16_f32 v149, v234, v235
    v_mfma_f32_16x16x32_bf16 v[64:67], a[100:103], v[136:139], v[64:67]
    ds_read_b64_tr_b16 a[18:19], v3 offset:18432
    v_cvt_pk_bf16_f32 v150, v236, v237
    v_mfma_f32_16x16x32_bf16 v[72:75], a[100:103], v[140:143], v[72:75]
    ds_read_b64_tr_b16 a[20:21], v3 offset:20480
    v_cvt_pk_bf16_f32 v151, v238, v239
    v_mfma_f32_16x16x32_bf16 v[68:71], a[116:119], v[136:139], v[68:71]
    buffer_load_dwordx4 v13, s[48:51], s33 offen offset:3072  lds
    s_add_u32 m0, s38, 98304
    v_mfma_f32_16x16x32_bf16 v[76:79], a[116:119], v[140:143], v[76:79]
    ds_read_b64_tr_b16 a[22:23], v3 offset:22528
    s_xor_b32 s33, s26, 16384
    v_mfma_f32_16x16x32_bf16 v[80:83], a[72:75], v[144:147], v[80:83]
    ds_read_b64_tr_b16 a[24:25], v3 offset:24576
    ds_read_b64_tr_b16 a[26:27], v3 offset:26624
    v_mfma_f32_16x16x32_bf16 v[88:91], a[72:75], v[148:151], v[88:91]
    ds_read_b64_tr_b16 a[28:29], v3 offset:28672
    ds_read_b64_tr_b16 a[30:31], v3 offset:30720
    v_mfma_f32_16x16x32_bf16 v[84:87], a[88:91], v[144:147], v[84:87]
    buffer_load_dwordx4 v12, s[48:51], s33 offen offset:0 nt lds
    s_waitcnt vmcnt(10)
    v_mfma_f32_16x16x32_bf16 v[92:95], a[88:91], v[148:151], v[92:95]
    ds_read_b64_tr_b16 a[32:33], v0 offset:16384
    ds_read_b64_tr_b16 a[34:35], v0 offset:18432
    v_mfma_f32_16x16x32_bf16 v[64:67], a[104:107], v[144:147], v[64:67]
    ds_read_b64_tr_b16 a[36:37], v0 offset:20480
    ds_read_b64_tr_b16 a[38:39], v0 offset:22528
    v_mfma_f32_16x16x32_bf16 v[72:75], a[104:107], v[148:151], v[72:75]
    ds_read_b64_tr_b16 a[40:41], v0 offset:24576
    ds_read_b64_tr_b16 a[42:43], v0 offset:26624
    v_mfma_f32_16x16x32_bf16 v[68:71], a[120:123], v[144:147], v[68:71]
    buffer_load_dwordx4 v13, s[48:51], s33 offen offset:1024 nt lds
    s_xor_b32 s31, s12, 4096
    v_cvt_pk_bf16_f32 v152, v240, v241
    v_mfma_f32_16x16x32_bf16 v[76:79], a[120:123], v[148:151], v[76:79]
    s_atomic_add s25, s[8:9], s31
    v_cvt_pk_bf16_f32 v153, v242, v243
    v_cvt_pk_bf16_f32 v154, v244, v245
    v_cvt_pk_bf16_f32 v155, v246, v247
    s_nop 1
    s_waitcnt lgkmcnt(6)
    v_mfma_f32_16x16x32_bf16 v[80:83], a[76:79], v[152:155], v[80:83]
    ds_read_b64_tr_b16 a[44:45], v0 offset:28672
    ds_read_b64_tr_b16 a[46:47], v0 offset:30720
    v_cvt_pk_bf16_f32 v156, v248, v249
    v_cvt_pk_bf16_f32 v157, v250, v251
    v_cvt_pk_bf16_f32 v158, v252, v253
    v_cvt_pk_bf16_f32 v159, v254, v255
    s_nop 1
    v_mfma_f32_16x16x32_bf16 v[88:91], a[76:79], v[156:159], v[88:91]
    ds_read_b64_tr_b16 a[48:49], v1 offset:16384
    ds_read_b64_tr_b16 a[50:51], v1 offset:18432
    v_mfma_f32_16x16x32_bf16 v[84:87], a[92:95], v[152:155], v[84:87]
    buffer_load_dwordx4 v12, s[48:51], s33 offen offset:2048 nt lds
    s_xor_b32 s31, s12, 4224
    v_mfma_f32_16x16x32_bf16 v[92:95], a[92:95], v[156:159], v[92:95]
    s_atomic_add s25, s[8:9], s31
    ds_read_b64_tr_b16 a[52:53], v1 offset:20480
    v_mfma_f32_16x16x32_bf16 v[64:67], a[108:111], v[152:155], v[64:67]
    ds_read_b64_tr_b16 a[54:55], v1 offset:22528
    ds_read_b64_tr_b16 a[56:57], v1 offset:24576
    v_mfma_f32_16x16x32_bf16 v[72:75], a[108:111], v[156:159], v[72:75]
    ds_read_b64_tr_b16 a[58:59], v1 offset:26624
    ds_read_b64_tr_b16 a[60:61], v1 offset:28672
    v_mfma_f32_16x16x32_bf16 v[68:71], a[124:127], v[152:155], v[68:71]
    buffer_load_dwordx4 v13, s[48:51], s33 offen offset:3072 nt lds
    v_mfma_f32_16x16x32_bf16 v[76:79], a[124:127], v[156:159], v[76:79]
    ds_read_b64_tr_b16 a[62:63], v1 offset:30720
    s_waitcnt vmcnt(20)
    s_barrier
    v_mfma_f32_16x16x32_bf16 v[112:115], a[0:3], v[128:131], 0
    ds_read_b64_tr_b16 a[64:65], v2 offset:32768
    s_add_u32 m0, s38, 102400
    v_mfma_f32_16x16x32_bf16 v[112:115], a[4:7], v[136:139], v[112:115]
    ds_read_b64_tr_b16 a[66:67], v2 offset:34816
    s_xor_b32 s33, s26, 20480
    v_mfma_f32_16x16x32_bf16 v[112:115], a[8:11], v[144:147], v[112:115]
    buffer_load_dwordx4 v12, s[48:51], s33 offen offset:0 nt lds
    v_mfma_f32_16x16x32_bf16 v[112:115], a[12:15], v[152:155], v[112:115]
    ds_read_b64_tr_b16 a[68:69], v2 offset:36864
    ds_read_b64_tr_b16 a[70:71], v2 offset:38912
    v_mfma_f32_16x16x32_bf16 v[120:123], a[0:3], v[132:135], 0
    ds_read_b64_tr_b16 a[72:73], v2 offset:40960
    ds_read_b64_tr_b16 a[74:75], v2 offset:43008
    v_mfma_f32_16x16x32_bf16 v[120:123], a[4:7], v[140:143], v[120:123]
    ds_read_b64_tr_b16 a[76:77], v2 offset:45056
    ds_read_b64_tr_b16 a[78:79], v2 offset:47104
    v_mfma_f32_16x16x32_bf16 v[120:123], a[8:11], v[148:151], v[120:123]
    buffer_load_dwordx4 v13, s[48:51], s33 offen offset:1024 nt lds
    v_mfma_f32_16x16x32_bf16 v[120:123], a[12:15], v[156:159], v[120:123]
    ds_read_b64_tr_b16 a[80:81], v3 offset:32768
    ds_read_b64_tr_b16 a[82:83], v3 offset:34816
    v_mfma_f32_16x16x32_bf16 v[116:119], a[16:19], v[128:131], 0
    ds_read_b64_tr_b16 a[84:85], v3 offset:36864
    ds_read_b64_tr_b16 a[86:87], v3 offset:38912
    v_mfma_f32_16x16x32_bf16 v[116:119], a[20:23], v[136:139], v[116:119]
    ds_read_b64_tr_b16 a[88:89], v3 offset:40960
    ds_read_b64_tr_b16 a[90:91], v3 offset:43008
    v_mfma_f32_16x16x32_bf16 v[116:119], a[24:27], v[144:147], v[116:119]
    buffer_load_dwordx4 v12, s[48:51], s33 offen offset:2048 nt lds
    v_mfma_f32_16x16x32_bf16 v[116:119], a[28:31], v[152:155], v[116:119]
    ds_read_b64_tr_b16 a[92:93], v3 offset:45056
    ds_read_b64_tr_b16 a[94:95], v3 offset:47104
    v_mfma_f32_16x16x32_bf16 v[124:127], a[16:19], v[132:135], 0
    ds_read_b64_tr_b16 a[96:97], v0 offset:32768
    ds_read_b64_tr_b16 a[98:99], v0 offset:34816
    v_mfma_f32_16x16x32_bf16 v[124:127], a[20:23], v[140:143], v[124:127]
    ds_read_b64_tr_b16 a[100:101], v0 offset:36864
    ds_read_b64_tr_b16 a[102:103], v0 offset:38912
    v_mfma_f32_16x16x32_bf16 v[124:127], a[24:27], v[148:151], v[124:127]
    buffer_load_dwordx4 v13, s[48:51], s33 offen offset:3072 nt lds
    s_add_u32 m0, s37, 0
    v_mfma_f32_16x16x32_bf16 v[124:127], a[28:31], v[156:159], v[124:127]
    ds_read_b64_tr_b16 a[104:105], v0 offset:40960
    s_waitcnt lgkmcnt(7)
    v_mfma_f32_16x16x32_bf16 v[96:99], a[32:35], v[128:131], 0
    s_load_dword s10, s[8:9], s12 glc
    s_xor_b32 s33, s32, 131328
    v_mfma_f32_16x16x32_bf16 v[96:99], a[36:39], v[136:139], v[96:99]
    ds_read_b64_tr_b16 a[106:107], v0 offset:43008
    v_mfma_f32_16x16x32_bf16 v[96:99], a[40:43], v[144:147], v[96:99]
    buffer_load_dwordx4 v8, s[56:59], s33 offen offset:0  lds
    v_mfma_f32_16x16x32_bf16 v[96:99], a[44:47], v[152:155], v[96:99]
    ds_read_b64_tr_b16 a[108:109], v0 offset:45056
    v_mfma_f32_16x16x32_bf16 v[104:107], a[32:35], v[132:135], 0
    ds_read_b64_tr_b16 a[110:111], v0 offset:47104
    v_mfma_f32_16x16x32_bf16 v[104:107], a[36:39], v[140:143], v[104:107]
    ds_read_b64_tr_b16 a[112:113], v1 offset:32768
    v_mfma_f32_16x16x32_bf16 v[104:107], a[40:43], v[148:151], v[104:107]
    buffer_load_dwordx4 v9, s[56:59], s33 offen offset:1024  lds
    v_mfma_f32_16x16x32_bf16 v[104:107], a[44:47], v[156:159], v[104:107]
    ds_read_b64_tr_b16 a[114:115], v1 offset:34816
    v_mfma_f32_16x16x32_bf16 v[100:103], a[48:51], v[128:131], 0
    ds_read_b64_tr_b16 a[116:117], v1 offset:36864
    v_mfma_f32_16x16x32_bf16 v[100:103], a[52:55], v[136:139], v[100:103]
    ds_read_b64_tr_b16 a[118:119], v1 offset:38912
    v_mfma_f32_16x16x32_bf16 v[100:103], a[56:59], v[144:147], v[100:103]
    buffer_load_dwordx4 v10, s[56:59], s33 offen offset:2048  lds
    v_mfma_f32_16x16x32_bf16 v[100:103], a[60:63], v[152:155], v[100:103]
    ds_read_b64_tr_b16 a[120:121], v1 offset:40960
    v_mfma_f32_16x16x32_bf16 v[108:111], a[48:51], v[132:135], 0
    ds_read_b64_tr_b16 a[122:123], v1 offset:43008
    v_mfma_f32_16x16x32_bf16 v[108:111], a[52:55], v[140:143], v[108:111]
    ds_read_b64_tr_b16 a[124:125], v1 offset:45056
    v_mfma_f32_16x16x32_bf16 v[108:111], a[56:59], v[148:151], v[108:111]
    buffer_load_dwordx4 v11, s[56:59], s33 offen offset:3072  lds
    v_mfma_f32_16x16x32_bf16 v[108:111], a[60:63], v[156:159], v[108:111]
    ds_read_b64_tr_b16 a[126:127], v1 offset:47104
    s_waitcnt vmcnt(12)
    s_barrier
    v_mfma_f32_16x16x32_bf16 v[48:51], a[64:67], v[128:131], 0
    ds_read_b64_tr_b16 a[224:225], v16 offset:0
    s_add_u32 m0, s37, 16384
    v_mfma_f32_16x16x32_bf16 v[48:51], a[68:71], v[136:139], v[48:51]
    ds_read_b64_tr_b16 a[226:227], v16 offset:4096
    s_xor_b32 s33, s32, 131456
    v_mfma_f32_16x16x32_bf16 v[48:51], a[72:75], v[144:147], v[48:51]
    buffer_load_dwordx4 v8, s[56:59], s33 offen offset:0  lds
    v_mfma_f32_16x16x32_bf16 v[48:51], a[76:79], v[152:155], v[48:51]
    ds_read_b64_tr_b16 a[228:229], v17 offset:0
    ds_read_b64_tr_b16 a[230:231], v17 offset:4096
    v_mfma_f32_16x16x32_bf16 v[56:59], a[64:67], v[132:135], 0
    ds_read_b64_tr_b16 a[232:233], v18 offset:0
    ds_read_b64_tr_b16 a[234:235], v18 offset:4096
    v_mfma_f32_16x16x32_bf16 v[56:59], a[68:71], v[140:143], v[56:59]
    ds_read_b64_tr_b16 a[236:237], v19 offset:0
    ds_read_b64_tr_b16 a[238:239], v19 offset:4096
    v_mfma_f32_16x16x32_bf16 v[56:59], a[72:75], v[148:151], v[56:59]
    buffer_load_dwordx4 v9, s[56:59], s33 offen offset:1024  lds
    v_mfma_f32_16x16x32_bf16 v[56:59], a[76:79], v[156:159], v[56:59]
    ds_read_b64_tr_b16 a[240:241], v20 offset:0
    s_waitcnt lgkmcnt(7)
    v_mfma_f32_16x16x32_bf16 v[192:195], a[224:227], a[168:171], 0
    ds_read_b64_tr_b16 a[242:243], v20 offset:4096
    s_waitcnt lgkmcnt(6)
    v_mfma_f32_16x16x32_bf16 v[196:199], a[228:231], a[168:171], 0
    ds_read_b64_tr_b16 a[244:245], v21 offset:0
    ds_read_b64_tr_b16 a[246:247], v21 offset:4096
    v_mfma_f32_16x16x32_bf16 v[200:203], a[224:227], a[172:175], 0
    buffer_load_dwordx4 v10, s[56:59], s33 offen offset:2048  lds
    v_mfma_f32_16x16x32_bf16 v[204:207], a[228:231], a[172:175], 0
    ds_read_b64_tr_b16 a[248:249], v22 offset:0
    ds_read_b64_tr_b16 a[250:251], v22 offset:4096
    v_mfma_f32_16x16x32_bf16 v[52:55], a[80:83], v[128:131], 0
    ds_read_b64_tr_b16 a[252:253], v23 offset:0
    ds_read_b64_tr_b16 a[254:255], v23 offset:4096
    v_mfma_f32_16x16x32_bf16 v[52:55], a[84:87], v[136:139], v[52:55]
    ds_read_b64_tr_b16 a[0:1], v2 offset:49152
    ds_read_b64_tr_b16 a[2:3], v2 offset:51200
    v_mfma_f32_16x16x32_bf16 v[52:55], a[88:91], v[144:147], v[52:55]
    buffer_load_dwordx4 v11, s[56:59], s33 offen offset:3072  lds
    s_add_u32 m0, s37, 131072
    v_mfma_f32_16x16x32_bf16 v[52:55], a[92:95], v[152:155], v[52:55]
    ds_read_b64_tr_b16 a[4:5], v2 offset:53248
    s_waitcnt lgkmcnt(7)
    v_mfma_f32_16x16x32_bf16 v[208:211], a[232:235], a[168:171], 0
    ds_read_b64_tr_b16 a[6:7], v2 offset:55296
    s_xor_b32 s33, s32, 262272
    v_mfma_f32_16x16x32_bf16 v[212:215], a[236:239], a[168:171], 0
    ds_read_b64_tr_b16 a[8:9], v2 offset:57344
    v_cvt_pk_bf16_f32 v160, v192, v193
    v_mfma_f32_16x16x32_bf16 v[216:219], a[232:235], a[172:175], 0
    buffer_load_dwordx4 v8, s[56:59], s33 offen offset:0  lds
    v_cvt_pk_bf16_f32 v161, v194, v195
    v_mfma_f32_16x16x32_bf16 v[220:223], a[236:239], a[172:175], 0
    ds_read_b64_tr_b16 a[10:11], v2 offset:59392
    v_cvt_pk_bf16_f32 v162, v196, v197
    v_mfma_f32_16x16x32_bf16 v[60:63], a[80:83], v[132:135], 0
    ds_read_b64_tr_b16 a[12:13], v2 offset:61440
    v_cvt_pk_bf16_f32 v163, v198, v199
    v_mfma_f32_16x16x32_bf16 v[60:63], a[84:87], v[140:143], v[60:63]
    ds_read_b64_tr_b16 a[14:15], v2 offset:63488
    v_cvt_pk_bf16_f32 v164, v200, v201
    v_mfma_f32_16x16x32_bf16 v[60:63], a[88:91], v[148:151], v[60:63]
    buffer_load_dwordx4 v9, s[56:59], s33 offen offset:1024  lds
    v_cvt_pk_bf16_f32 v165, v202, v203
    v_mfma_f32_16x16x32_bf16 v[60:63], a[92:95], v[156:159], v[60:63]
    ds_read_b64_tr_b16 a[16:17], v3 offset:49152
    v_cvt_pk_bf16_f32 v166, v204, v205
    v_mfma_f32_16x16x32_bf16 v[224:227], a[240:243], a[168:171], 0
    ds_read_b64_tr_b16 a[18:19], v3 offset:51200
    v_cvt_pk_bf16_f32 v167, v206, v207
    v_mfma_f32_16x16x32_bf16 v[228:231], a[244:247], a[168:171], 0
    ds_read_b64_tr_b16 a[20:21], v3 offset:53248
    v_cvt_pk_bf16_f32 v168, v208, v209
    v_mfma_f32_16x16x32_bf16 v[232:235], a[240:243], a[172:175], 0
    buffer_load_dwordx4 v10, s[56:59], s33 offen offset:2048  lds
    v_cvt_pk_bf16_f32 v169, v210, v211
    v_mfma_f32_16x16x32_bf16 v[236:239], a[244:247], a[172:175], 0
    ds_read_b64_tr_b16 a[22:23], v3 offset:55296
    v_cvt_pk_bf16_f32 v170, v212, v213
    v_mfma_f32_16x16x32_bf16 v[32:35], a[96:99], v[128:131], 0
    ds_read_b64_tr_b16 a[24:25], v3 offset:57344
    v_cvt_pk_bf16_f32 v171, v214, v215
    v_mfma_f32_16x16x32_bf16 v[32:35], a[100:103], v[136:139], v[32:35]
    ds_read_b64_tr_b16 a[26:27], v3 offset:59392
    v_cvt_pk_bf16_f32 v172, v216, v217
    v_mfma_f32_16x16x32_bf16 v[32:35], a[104:107], v[144:147], v[32:35]
    buffer_load_dwordx4 v11, s[56:59], s33 offen offset:3072  lds
    v_cvt_pk_bf16_f32 v173, v218, v219
    v_mfma_f32_16x16x32_bf16 v[32:35], a[108:111], v[152:155], v[32:35]
    ds_read_b64_tr_b16 a[28:29], v3 offset:61440
    v_cvt_pk_bf16_f32 v174, v220, v221
    s_waitcnt lgkmcnt(4)
    v_mfma_f32_16x16x32_bf16 v[240:243], a[248:251], a[168:171], 0
    ds_read_b64_tr_b16 a[30:31], v3 offset:63488
    v_cvt_pk_bf16_f32 v175, v222, v223
    v_mfma_f32_16x16x32_bf16 v[244:247], a[252:255], a[168:171], 0
    ds_read_b64_tr_b16 a[32:33], v0 offset:49152
    v_cvt_pk_bf16_f32 v176, v224, v225
    v_mfma_f32_16x16x32_bf16 v[248:251], a[248:251], a[172:175], 0
    ds_read_b64_tr_b16 a[34:35], v0 offset:51200
    v_cvt_pk_bf16_f32 v177, v226, v227
    v_mfma_f32_16x16x32_bf16 v[252:255], a[252:255], a[172:175], 0
    ds_read_b64_tr_b16 a[36:37], v0 offset:53248
    v_cvt_pk_bf16_f32 v178, v228, v229
    v_mfma_f32_16x16x32_bf16 v[40:43], a[96:99], v[132:135], 0
    ds_read_b64_tr_b16 a[38:39], v0 offset:55296
    v_cvt_pk_bf16_f32 v179, v230, v231
    v_mfma_f32_16x16x32_bf16 v[40:43], a[100:103], v[140:143], v[40:43]
    ds_read_b64_tr_b16 a[40:41], v0 offset:57344
    v_cvt_pk_bf16_f32 v180, v232, v233
    v_mfma_f32_16x16x32_bf16 v[40:43], a[104:107], v[148:151], v[40:43]
    ds_read_b64_tr_b16 a[42:43], v0 offset:59392
    v_cvt_pk_bf16_f32 v181, v234, v235
    v_mfma_f32_16x16x32_bf16 v[40:43], a[108:111], v[156:159], v[40:43]
    ds_read_b64_tr_b16 a[44:45], v0 offset:61440
    v_cvt_pk_bf16_f32 v182, v236, v237
    v_mfma_f32_16x16x32_bf16 v[36:39], a[112:115], v[128:131], 0
    ds_read_b64_tr_b16 a[46:47], v0 offset:63488
    v_cvt_pk_bf16_f32 v183, v238, v239
    v_mfma_f32_16x16x32_bf16 v[36:39], a[116:119], v[136:139], v[36:39]
    ds_read_b64_tr_b16 a[48:49], v1 offset:49152
    v_cvt_pk_bf16_f32 v184, v240, v241
    v_mfma_f32_16x16x32_bf16 v[36:39], a[120:123], v[144:147], v[36:39]
    ds_read_b64_tr_b16 a[50:51], v1 offset:51200
    v_cvt_pk_bf16_f32 v185, v242, v243
    v_mfma_f32_16x16x32_bf16 v[36:39], a[124:127], v[152:155], v[36:39]
    ds_read_b64_tr_b16 a[52:53], v1 offset:53248
    v_cvt_pk_bf16_f32 v186, v244, v245
    v_mfma_f32_16x16x32_bf16 v[44:47], a[112:115], v[132:135], 0
    ds_read_b64_tr_b16 a[54:55], v1 offset:55296
    v_cvt_pk_bf16_f32 v187, v246, v247
    v_mfma_f32_16x16x32_bf16 v[44:47], a[116:119], v[140:143], v[44:47]
    ds_read_b64_tr_b16 a[56:57], v1 offset:57344
    ds_read_b64_tr_b16 a[58:59], v1 offset:59392
    v_cvt_pk_bf16_f32 v188, v248, v249
    v_mfma_f32_16x16x32_bf16 v[44:47], a[120:123], v[148:151], v[44:47]
    ds_read_b64_tr_b16 a[60:61], v1 offset:61440
    v_cvt_pk_bf16_f32 v189, v250, v251
    v_mfma_f32_16x16x32_bf16 v[44:47], a[124:127], v[156:159], v[44:47]
    ds_read_b64_tr_b16 a[62:63], v1 offset:63488
    v_cvt_pk_bf16_f32 v190, v252, v253
    v_cvt_pk_bf16_f32 v191, v254, v255
    s_waitcnt vmcnt(8)
    s_barrier
    v_mfma_f32_16x16x32_bf16 v[80:83], a[0:3], v[160:163], v[80:83]
    ds_read_b64_tr_b16 a[64:65], v2 offset:0
    s_bitcmp1_b32 s10, 17
    s_cbranch_scc0 L_cP
L_cP_ok:
    v_mfma_f32_16x16x32_bf16 v[80:83], a[4:7], v[168:171], v[80:83]
    ds_read_b64_tr_b16 a[66:67], v2 offset:2048
    s_add_u32 s100, s27, 0
    v_mfma_f32_16x16x32_bf16 v[80:83], a[8:11], v[176:179], v[80:83]
    buffer_load_dwordx4 a[176:179], v14, s[60:63], s100 offen offset:0 sc1
    v_mfma_f32_16x16x32_bf16 v[80:83], a[12:15], v[184:187], v[80:83]
    ds_read_b64_tr_b16 a[68:69], v2 offset:4096
    ds_read_b64_tr_b16 a[70:71], v2 offset:6144
    v_mfma_f32_16x16x32_bf16 v[88:91], a[0:3], v[164:167], v[88:91]
    ds_read_b64_tr_b16 a[72:73], v2 offset:8192
    ds_read_b64_tr_b16 a[74:75], v2 offset:10240
    v_mfma_f32_16x16x32_bf16 v[88:91], a[4:7], v[172:175], v[88:91]
    ds_read_b64_tr_b16 a[76:77], v2 offset:12288
    ds_read_b64_tr_b16 a[78:79], v2 offset:14336
    v_mfma_f32_16x16x32_bf16 v[88:91], a[8:11], v[180:183], v[88:91]
    buffer_load_dwordx4 a[180:183], v14, s[60:63], s100 offen offset:1024 sc1
    s_add_u32 s100, s27, 4096
    v_mfma_f32_16x16x32_bf16 v[88:91], a[12:15], v[188:191], v[88:91]
    ds_read_b64_tr_b16 a[80:81], v3 offset:0
    ds_read_b64_tr_b16 a[82:83], v3 offset:2048
    v_mfma_f32_16x16x32_bf16 v[84:87], a[16:19], v[160:163], v[84:87]
    ds_read_b64_tr_b16 a[84:85], v3 offset:4096
    s_waitcnt lgkmcnt(9)
    v_mfma_f32_16x16x32_bf16 v[84:87], a[20:23], v[168:171], v[84:87]
    ds_read_b64_tr_b16 a[86:87], v3 offset:6144
    ds_read_b64_tr_b16 a[88:89], v3 offset:8192
    v_mfma_f32_16x16x32_bf16 v[84:87], a[24:27], v[176:179], v[84:87]
    buffer_load_dwordx4 a[184:187], v14, s[60:63], s100 offen offset:0 sc1
    v_mfma_f32_16x16x32_bf16 v[84:87], a[28:31], v[184:187], v[84:87]
    ds_read_b64_tr_b16 a[90:91], v3 offset:10240
    ds_read_b64_tr_b16 a[92:93], v3 offset:12288
    v_mfma_f32_16x16x32_bf16 v[92:95], a[16:19], v[164:167], v[92:95]
    ds_read_b64_tr_b16 a[94:95], v3 offset:14336
    ds_read_b64_tr_b16 a[96:97], v0 offset:0
    v_mfma_f32_16x16x32_bf16 v[92:95], a[20:23], v[172:175], v[92:95]
    ds_read_b64_tr_b16 a[98:99], v0 offset:2048
    ds_read_b64_tr_b16 a[100:101], v0 offset:4096
    v_mfma_f32_16x16x32_bf16 v[92:95], a[24:27], v[180:183], v[92:95]
    buffer_load_dwordx4 a[188:191], v14, s[60:63], s100 offen offset:1024 sc1
    s_add_u32 m0, s37, 32768
    v_mfma_f32_16x16x32_bf16 v[92:95], a[28:31], v[188:191], v[92:95]
    ds_read_b64_tr_b16 a[102:103], v0 offset:6144
    s_xor_b32 s33, s32, 393344
    v_mfma_f32_16x16x32_bf16 v[64:67], a[32:35], v[160:163], v[64:67]
    ds_read_b64_tr_b16 a[104:105], v0 offset:8192
    v_mfma_f32_16x16x32_bf16 v[64:67], a[36:39], v[168:171], v[64:67]
    ds_read_b64_tr_b16 a[106:107], v0 offset:10240
    v_mfma_f32_16x16x32_bf16 v[64:67], a[40:43], v[176:179], v[64:67]
    buffer_load_dwordx4 v8, s[56:59], s33 offen offset:0  lds
    v_mfma_f32_16x16x32_bf16 v[64:67], a[44:47], v[184:187], v[64:67]
    ds_read_b64_tr_b16 a[108:109], v0 offset:12288
    v_mfma_f32_16x16x32_bf16 v[72:75], a[32:35], v[164:167], v[72:75]
    ds_read_b64_tr_b16 a[110:111], v0 offset:14336
    v_mfma_f32_16x16x32_bf16 v[72:75], a[36:39], v[172:175], v[72:75]
    ds_read_b64_tr_b16 a[112:113], v1 offset:0
    v_mfma_f32_16x16x32_bf16 v[72:75], a[40:43], v[180:183], v[72:75]
    buffer_load_dwordx4 v9, s[56:59], s33 offen offset:1024  lds
    v_mfma_f32_16x16x32_bf16 v[72:75], a[44:47], v[188:191], v[72:75]
    ds_read_b64_tr_b16 a[114:115], v1 offset:2048
    v_mfma_f32_16x16x32_bf16 v[68:71], a[48:51], v[160:163], v[68:71]
    ds_read_b64_tr_b16 a[116:117], v1 offset:4096
    v_mfma_f32_16x16x32_bf16 v[68:71], a[52:55], v[168:171], v[68:71]
    ds_read_b64_tr_b16 a[118:119], v1 offset:6144
    v_mfma_f32_16x16x32_bf16 v[68:71], a[56:59], v[176:179], v[68:71]
    buffer_load_dwordx4 v10, s[56:59], s33 offen offset:2048  lds
    v_mfma_f32_16x16x32_bf16 v[68:71], a[60:63], v[184:187], v[68:71]
    ds_read_b64_tr_b16 a[120:121], v1 offset:8192
    v_mfma_f32_16x16x32_bf16 v[76:79], a[48:51], v[164:167], v[76:79]
    ds_read_b64_tr_b16 a[122:123], v1 offset:10240
    v_mfma_f32_16x16x32_bf16 v[76:79], a[52:55], v[172:175], v[76:79]
    ds_read_b64_tr_b16 a[124:125], v1 offset:12288
    v_mfma_f32_16x16x32_bf16 v[76:79], a[56:59], v[180:183], v[76:79]
    buffer_load_dwordx4 v11, s[56:59], s33 offen offset:3072  lds
    v_mfma_f32_16x16x32_bf16 v[76:79], a[60:63], v[188:191], v[76:79]
    ds_read_b64_tr_b16 a[126:127], v1 offset:14336
    s_waitcnt vmcnt(12)
    s_barrier
    v_mfma_f32_16x16x32_bf16 v[112:115], a[64:67], v[160:163], v[112:115]
    ds_read_b64_tr_b16 a[0:1], v2 offset:16384
    s_waitcnt lgkmcnt(5)
    v_mfma_f32_16x16x32_bf16 v[112:115], a[68:71], v[168:171], v[112:115]
    ds_read_b64_tr_b16 a[2:3], v2 offset:18432
    s_add_u32 m0, s38, 65536
    v_mfma_f32_16x16x32_bf16 v[112:115], a[72:75], v[176:179], v[112:115]
    ds_read_b64_tr_b16 a[4:5], v2 offset:20480
    s_xor_b32 s33, s26, 24576
    v_mfma_f32_16x16x32_bf16 v[112:115], a[76:79], v[184:187], v[112:115]
    buffer_load_dwordx4 v12, s[48:51], s33 offen offset:0 nt lds
    v_mfma_f32_16x16x32_bf16 v[120:123], a[64:67], v[164:167], v[120:123]
    ds_read_b64_tr_b16 a[6:7], v2 offset:22528
    ds_read_b64_tr_b16 a[8:9], v2 offset:24576
    v_mfma_f32_16x16x32_bf16 v[120:123], a[68:71], v[172:175], v[120:123]
    ds_read_b64_tr_b16 a[10:11], v2 offset:26624
    ds_read_b64_tr_b16 a[12:13], v2 offset:28672
    v_mfma_f32_16x16x32_bf16 v[120:123], a[72:75], v[180:183], v[120:123]
    ds_read_b64_tr_b16 a[14:15], v2 offset:30720
    ds_read_b64_tr_b16 a[16:17], v3 offset:16384
    v_mfma_f32_16x16x32_bf16 v[120:123], a[76:79], v[188:191], v[120:123]
    buffer_load_dwordx4 v13, s[48:51], s33 offen offset:1024 nt lds
    v_mfma_f32_16x16x32_bf16 v[116:119], a[80:83], v[160:163], v[116:119]
    ds_read_b64_tr_b16 a[18:19], v3 offset:18432
    ds_read_b64_tr_b16 a[20:21], v3 offset:20480
    v_mfma_f32_16x16x32_bf16 v[116:119], a[84:87], v[168:171], v[116:119]
    ds_read_b64_tr_b16 a[22:23], v3 offset:22528
    ds_read_b64_tr_b16 a[24:25], v3 offset:24576
    v_mfma_f32_16x16x32_bf16 v[116:119], a[88:91], v[176:179], v[116:119]
    ds_read_b64_tr_b16 a[26:27], v3 offset:26624
    ds_read_b64_tr_b16 a[28:29], v3 offset:28672
    v_mfma_f32_16x16x32_bf16 v[116:119], a[92:95], v[184:187], v[116:119]
    buffer_load_dwordx4 v12, s[48:51], s33 offen offset:2048 nt lds
    v_mfma_f32_16x16x32_bf16 v[124:127], a[80:83], v[164:167], v[124:127]
    ds_read_b64_tr_b16 a[30:31], v3 offset:30720
    ds_read_b64_tr_b16 a[32:33], v0 offset:16384
    v_mfma_f32_16x16x32_bf16 v[124:127], a[84:87], v[172:175], v[124:127]
    ds_read_b64_tr_b16 a[34:35], v0 offset:18432
    ds_read_b64_tr_b16 a[36:37], v0 offset:20480
    v_mfma_f32_16x16x32_bf16 v[124:127], a[88:91], v[180:183], v[124:127]
    ds_read_b64_tr_b16 a[38:39], v0 offset:22528
    v_mfma_f32_16x16x32_bf16 v[124:127], a[92:95], v[188:191], v[124:127]
    buffer_load_dwordx4 v13, s[48:51], s33 offen offset:3072 nt lds
    s_add_u32 m0, s38, 69632
    v_mfma_f32_16x16x32_bf16 v[96:99], a[96:99], v[160:163], v[96:99]
    ds_read_b64_tr_b16 a[40:41], v0 offset:24576
    s_xor_b32 s33, s26, 28672
    v_mfma_f32_16x16x32_bf16 v[96:99], a[100:103], v[168:171], v[96:99]
    ds_read_b64_tr_b16 a[42:43], v0 offset:26624
    v_mfma_f32_16x16x32_bf16 v[96:99], a[104:107], v[176:179], v[96:99]
    ds_read_b64_tr_b16 a[44:45], v0 offset:28672
    v_mfma_f32_16x16x32_bf16 v[96:99], a[108:111], v[184:187], v[96:99]
    buffer_load_dwordx4 v12, s[48:51], s33 offen offset:0 nt lds
    v_mfma_f32_16x16x32_bf16 v[104:107], a[96:99], v[164:167], v[104:107]
    ds_read_b64_tr_b16 a[46:47], v0 offset:30720
    v_mfma_f32_16x16x32_bf16 v[104:107], a[100:103], v[172:175], v[104:107]
    ds_read_b64_tr_b16 a[48:49], v1 offset:16384
    v_mfma_f32_16x16x32_bf16 v[104:107], a[104:107], v[180:183], v[104:107]
    ds_read_b64_tr_b16 a[50:51], v1 offset:18432
    v_mfma_f32_16x16x32_bf16 v[104:107], a[108:111], v[188:191], v[104:107]
    buffer_load_dwordx4 v13, s[48:51], s33 offen offset:1024 nt lds
    v_mfma_f32_16x16x32_bf16 v[100:103], a[112:115], v[160:163], v[100:103]
    ds_read_b64_tr_b16 a[52:53], v1 offset:20480
    v_mfma_f32_16x16x32_bf16 v[100:103], a[116:119], v[168:171], v[100:103]
    ds_read_b64_tr_b16 a[54:55], v1 offset:22528
    s_waitcnt lgkmcnt(5)
    v_mfma_f32_16x16x32_bf16 v[100:103], a[120:123], v[176:179], v[100:103]
    ds_read_b64_tr_b16 a[56:57], v1 offset:24576
    v_mfma_f32_16x16x32_bf16 v[100:103], a[124:127], v[184:187], v[100:103]
    buffer_load_dwordx4 v12, s[48:51], s33 offen offset:2048 nt lds
    v_mfma_f32_16x16x32_bf16 v[108:111], a[112:115], v[164:167], v[108:111]
    ds_read_b64_tr_b16 a[58:59], v1 offset:26624
    v_mfma_f32_16x16x32_bf16 v[108:111], a[116:119], v[172:175], v[108:111]
    ds_read_b64_tr_b16 a[60:61], v1 offset:28672
    v_mfma_f32_16x16x32_bf16 v[108:111], a[120:123], v[180:183], v[108:111]
    ds_read_b64_tr_b16 a[62:63], v1 offset:30720
    v_mfma_f32_16x16x32_bf16 v[108:111], a[124:127], v[188:191], v[108:111]
    buffer_load_dwordx4 v13, s[48:51], s33 offen offset:3072 nt lds
    s_waitcnt vmcnt(16)
    s_barrier
    v_mfma_f32_16x16x32_bf16 v[48:51], a[0:3], v[160:163], v[48:51]
    ds_read_b64_tr_b16 a[192:193], v16 offset:32768
    s_add_u32 m0, s37, 0
    v_mfma_f32_16x16x32_bf16 v[48:51], a[4:7], v[168:171], v[48:51]
    ds_read_b64_tr_b16 a[194:195], v16 offset:36864
    s_xor_b32 s33, s32, 262400
    v_mfma_f32_16x16x32_bf16 v[48:51], a[8:11], v[176:179], v[48:51]
    buffer_load_dwordx4 v8, s[56:59], s33 offen offset:0  lds
    v_mfma_f32_16x16x32_bf16 v[48:51], a[12:15], v[184:187], v[48:51]
    ds_read_b64_tr_b16 a[196:197], v17 offset:32768
    ds_read_b64_tr_b16 a[198:199], v17 offset:36864
    v_mfma_f32_16x16x32_bf16 v[56:59], a[0:3], v[164:167], v[56:59]
    ds_read_b64_tr_b16 a[200:201], v18 offset:32768
    ds_read_b64_tr_b16 a[202:203], v18 offset:36864
    v_mfma_f32_16x16x32_bf16 v[56:59], a[4:7], v[172:175], v[56:59]
    ds_read_b64_tr_b16 a[204:205], v19 offset:32768
    ds_read_b64_tr_b16 a[206:207], v19 offset:36864
    v_mfma_f32_16x16x32_bf16 v[56:59], a[8:11], v[180:183], v[56:59]
    buffer_load_dwordx4 v9, s[56:59], s33 offen offset:1024  lds
    s_waitcnt vmcnt(14)
    v_mfma_f32_16x16x32_bf16 v[56:59], a[12:15], v[188:191], v[56:59]
    ds_read_b64_tr_b16 a[208:209], v20 offset:32768
    s_waitcnt lgkmcnt(7)
    v_mfma_f32_16x16x32_bf16 v[224:227], a[192:195], a[176:179], 0
    ds_read_b64_tr_b16 a[210:211], v20 offset:36864
    s_waitcnt lgkmcnt(6)
    v_mfma_f32_16x16x32_bf16 v[228:231], a[196:199], a[176:179], 0
    ds_read_b64_tr_b16 a[212:213], v21 offset:32768
    ds_read_b64_tr_b16 a[214:215], v21 offset:36864
    v_mfma_f32_16x16x32_bf16 v[232:235], a[192:195], a[180:183], 0
    buffer_load_dwordx4 v10, s[56:59], s33 offen offset:2048  lds
    v_mfma_f32_16x16x32_bf16 v[236:239], a[196:199], a[180:183], 0
    ds_read_b64_tr_b16 a[216:217], v22 offset:32768
    ds_read_b64_tr_b16 a[218:219], v22 offset:36864
    v_mfma_f32_16x16x32_bf16 v[52:55], a[16:19], v[160:163], v[52:55]
    ds_read_b64_tr_b16 a[220:221], v23 offset:32768
    ds_read_b64_tr_b16 a[222:223], v23 offset:36864
    v_mfma_f32_16x16x32_bf16 v[52:55], a[20:23], v[168:171], v[52:55]
    ds_read_b64_tr_b16 a[64:65], v6 offset:32768
    ds_read_b64_tr_b16 a[66:67], v6 offset:34816
    v_mfma_f32_16x16x32_bf16 v[52:55], a[24:27], v[176:179], v[52:55]
    buffer_load_dwordx4 v11, s[56:59], s33 offen offset:3072  lds
    s_add_u32 m0, s37, 49152
    v_mfma_f32_16x16x32_bf16 v[52:55], a[28:31], v[184:187], v[52:55]
    ds_read_b64_tr_b16 a[68:69], v6 offset:36864
    s_waitcnt lgkmcnt(7)
    v_mfma_f32_16x16x32_bf16 v[240:243], a[200:203], a[176:179], 0
    ds_read_b64_tr_b16 a[70:71], v6 offset:38912
    s_xor_b32 s33, s32, 393472
    v_mfma_f32_16x16x32_bf16 v[244:247], a[204:207], a[176:179], 0
    ds_read_b64_tr_b16 a[72:73], v6 offset:40960
    v_cvt_pk_bf16_f32 v192, v224, v225
    v_mfma_f32_16x16x32_bf16 v[248:251], a[200:203], a[180:183], 0
    buffer_load_dwordx4 v8, s[56:59], s33 offen offset:0  lds
    v_cvt_pk_bf16_f32 v193, v226, v227
    v_mfma_f32_16x16x32_bf16 v[252:255], a[204:207], a[180:183], 0
    ds_read_b64_tr_b16 a[74:75], v6 offset:43008
    v_cvt_pk_bf16_f32 v194, v228, v229
    v_mfma_f32_16x16x32_bf16 v[60:63], a[16:19], v[164:167], v[60:63]
    ds_read_b64_tr_b16 a[76:77], v6 offset:45056
    v_cvt_pk_bf16_f32 v195, v230, v231
    v_mfma_f32_16x16x32_bf16 v[60:63], a[20:23], v[172:175], v[60:63]
    ds_read_b64_tr_b16 a[78:79], v6 offset:47104
    v_cvt_pk_bf16_f32 v196, v232, v233
    v_mfma_f32_16x16x32_bf16 v[60:63], a[24:27], v[180:183], v[60:63]
    buffer_load_dwordx4 v9, s[56:59], s33 offen offset:1024  lds
    v_cvt_pk_bf16_f32 v197, v234, v235
    v_mfma_f32_16x16x32_bf16 v[60:63], a[28:31], v[188:191], v[60:63]
    ds_read_b64_tr_b16 a[80:81], v7 offset:32768
    v_cvt_pk_bf16_f32 v198, v236, v237
    v_mfma_f32_16x16x32_bf16 v[224:227], a[208:211], a[176:179], 0
    ds_read_b64_tr_b16 a[82:83], v7 offset:34816
    v_cvt_pk_bf16_f32 v199, v238, v239
    v_mfma_f32_16x16x32_bf16 v[228:231], a[212:215], a[176:179], 0
    ds_read_b64_tr_b16 a[84:85], v7 offset:36864
    v_cvt_pk_bf16_f32 v200, v240, v241
    v_mfma_f32_16x16x32_bf16 v[232:235], a[208:211], a[180:183], 0
    buffer_load_dwordx4 v10, s[56:59], s33 offen offset:2048  lds
    v_cvt_pk_bf16_f32 v201, v242, v243
    v_mfma_f32_16x16x32_bf16 v[236:239], a[212:215], a[180:183], 0
    ds_read_b64_tr_b16 a[86:87], v7 offset:38912
    v_cvt_pk_bf16_f32 v202, v244, v245
    v_mfma_f32_16x16x32_bf16 v[32:35], a[32:35], v[160:163], v[32:35]
    ds_read_b64_tr_b16 a[88:89], v7 offset:40960
    v_cvt_pk_bf16_f32 v203, v246, v247
    v_mfma_f32_16x16x32_bf16 v[32:35], a[36:39], v[168:171], v[32:35]
    ds_read_b64_tr_b16 a[90:91], v7 offset:43008
    v_cvt_pk_bf16_f32 v204, v248, v249
    v_mfma_f32_16x16x32_bf16 v[32:35], a[40:43], v[176:179], v[32:35]
    buffer_load_dwordx4 v11, s[56:59], s33 offen offset:3072  lds
    s_add_u32 m0, s37, 147456
    v_mfma_f32_16x16x32_bf16 v[32:35], a[44:47], v[184:187], v[32:35]
    ds_read_b64_tr_b16 a[92:93], v7 offset:45056
    s_waitcnt lgkmcnt(4)
    v_mfma_f32_16x16x32_bf16 v[240:243], a[216:219], a[176:179], 0
    ds_read_b64_tr_b16 a[94:95], v7 offset:47104
    s_xor_b32 s33, s32, 262528
    v_cvt_pk_bf16_f32 v205, v250, v251
    v_mfma_f32_16x16x32_bf16 v[244:247], a[220:223], a[176:179], 0
    ds_read_b64_tr_b16 a[96:97], v4 offset:32768
    v_cvt_pk_bf16_f32 v206, v252, v253
    v_cvt_pk_bf16_f32 v207, v254, v255
    v_mfma_f32_16x16x32_bf16 v[248:251], a[216:219], a[180:183], 0
    buffer_load_dwordx4 v8, s[56:59], s33 offen offset:0  lds
    v_cvt_pk_bf16_f32 v208, v224, v225
    v_cvt_pk_bf16_f32 v209, v226, v227
    v_mfma_f32_16x16x32_bf16 v[252:255], a[220:223], a[180:183], 0
    ds_read_b64_tr_b16 a[98:99], v4 offset:34816
    v_cvt_pk_bf16_f32 v210, v228, v229
    v_mfma_f32_16x16x32_bf16 v[40:43], a[32:35], v[164:167], v[40:43]
    ds_read_b64_tr_b16 a[100:101], v4 offset:36864
    v_cvt_pk_bf16_f32 v211, v230, v231
    v_mfma_f32_16x16x32_bf16 v[40:43], a[36:39], v[172:175], v[40:43]
    ds_read_b64_tr_b16 a[102:103], v4 offset:38912
    v_cvt_pk_bf16_f32 v212, v232, v233
    v_mfma_f32_16x16x32_bf16 v[40:43], a[40:43], v[180:183], v[40:43]
    buffer_load_dwordx4 v9, s[56:59], s33 offen offset:1024  lds
    v_cvt_pk_bf16_f32 v213, v234, v235
    v_mfma_f32_16x16x32_bf16 v[40:43], a[44:47], v[188:191], v[40:43]
    ds_read_b64_tr_b16 a[104:105], v4 offset:40960
    ds_read_b64_tr_b16 a[106:107], v4 offset:43008
    v_cvt_pk_bf16_f32 v214, v236, v237
    v_mfma_f32_16x16x32_bf16 v[36:39], a[48:51], v[160:163], v[36:39]
    ds_read_b64_tr_b16 a[108:109], v4 offset:45056
    ds_read_b64_tr_b16 a[110:111], v4 offset:47104
    v_cvt_pk_bf16_f32 v215, v238, v239
    v_mfma_f32_16x16x32_bf16 v[36:39], a[52:55], v[168:171], v[36:39]
    ds_read_b64_tr_b16 a[112:113], v5 offset:32768
    ds_read_b64_tr_b16 a[114:115], v5 offset:34816
    v_cvt_pk_bf16_f32 v216, v240, v241
    v_mfma_f32_16x16x32_bf16 v[36:39], a[56:59], v[176:179], v[36:39]
    buffer_load_dwordx4 v10, s[56:59], s33 offen offset:2048  lds
    v_cvt_pk_bf16_f32 v217, v242, v243
    v_mfma_f32_16x16x32_bf16 v[36:39], a[60:63], v[184:187], v[36:39]
    ds_read_b64_tr_b16 a[116:117], v5 offset:36864
    ds_read_b64_tr_b16 a[118:119], v5 offset:38912
    v_cvt_pk_bf16_f32 v218, v244, v245
    v_mfma_f32_16x16x32_bf16 v[44:47], a[48:51], v[164:167], v[44:47]
    ds_read_b64_tr_b16 a[120:121], v5 offset:40960
    ds_read_b64_tr_b16 a[122:123], v5 offset:43008
    v_cvt_pk_bf16_f32 v219, v246, v247
    v_mfma_f32_16x16x32_bf16 v[44:47], a[52:55], v[172:175], v[44:47]
    ds_read_b64_tr_b16 a[124:125], v5 offset:45056
    v_cvt_pk_bf16_f32 v220, v248, v249
    v_mfma_f32_16x16x32_bf16 v[44:47], a[56:59], v[180:183], v[44:47]
    buffer_load_dwordx4 v11, s[56:59], s33 offen offset:3072  lds
    v_cvt_pk_bf16_f32 v221, v250, v251
    v_mfma_f32_16x16x32_bf16 v[44:47], a[60:63], v[188:191], v[44:47]
    ds_read_b64_tr_b16 a[126:127], v5 offset:47104
    v_cvt_pk_bf16_f32 v222, v252, v253
    v_cvt_pk_bf16_f32 v223, v254, v255
    s_waitcnt vmcnt(12)
    s_barrier
    v_mfma_f32_16x16x32_bf16 v[80:83], a[64:67], v[192:195], v[80:83]
    ds_read_b64_tr_b16 a[224:225], v16 offset:0
    s_add_u32 m0, s37, 16384
    v_mfma_f32_16x16x32_bf16 v[80:83], a[68:71], v[200:203], v[80:83]
    ds_read_b64_tr_b16 a[226:227], v16 offset:4096
    s_xor_b32 s33, s32, 393600
    v_mfma_f32_16x16x32_bf16 v[80:83], a[72:75], v[208:211], v[80:83]
    buffer_load_dwordx4 v8, s[56:59], s33 offen offset:0  lds
    v_mfma_f32_16x16x32_bf16 v[80:83], a[76:79], v[216:219], v[80:83]
    ds_read_b64_tr_b16 a[228:229], v17 offset:0
    ds_read_b64_tr_b16 a[230:231], v17 offset:4096
    v_mfma_f32_16x16x32_bf16 v[88:91], a[64:67], v[196:199], v[88:91]
    ds_read_b64_tr_b16 a[232:233], v18 offset:0
    ds_read_b64_tr_b16 a[234:235], v18 offset:4096
    v_mfma_f32_16x16x32_bf16 v[88:91], a[68:71], v[204:207], v[88:91]
    ds_read_b64_tr_b16 a[236:237], v19 offset:0
    s_waitcnt lgkmcnt(5)
    v_mfma_f32_16x16x32_bf16 v[224:227], a[224:227], a[184:187], 0
    buffer_load_dwordx4 v9, s[56:59], s33 offen offset:1024  lds
    s_waitcnt lgkmcnt(3)
    v_mfma_f32_16x16x32_bf16 v[228:231], a[228:231], a[184:187], 0
    ds_read_b64_tr_b16 a[238:239], v19 offset:4096
    ds_read_b64_tr_b16 a[240:241], v20 offset:0
    v_mfma_f32_16x16x32_bf16 v[24:27], a[224:227], a[188:191], 0
    ds_read_b64_tr_b16 a[242:243], v20 offset:4096
    ds_read_b64_tr_b16 a[244:245], v21 offset:0
    v_mfma_f32_16x16x32_bf16 v[28:31], a[228:231], a[188:191], 0
    ds_read_b64_tr_b16 a[246:247], v21 offset:4096
    ds_read_b64_tr_b16 a[248:249], v22 offset:0
    v_mfma_f32_16x16x32_bf16 v[88:91], a[72:75], v[212:215], v[88:91]
    buffer_load_dwordx4 v10, s[56:59], s33 offen offset:2048  lds
    v_mfma_f32_16x16x32_bf16 v[88:91], a[76:79], v[220:223], v[88:91]
    ds_read_b64_tr_b16 a[250:251], v22 offset:4096
    v_cvt_pk_bf16_f32 v224, v224, v225
    v_mfma_f32_16x16x32_bf16 v[84:87], a[80:83], v[192:195], v[84:87]
    ds_read_b64_tr_b16 a[252:253], v23 offset:0
    v_cvt_pk_bf16_f32 v225, v226, v227
    v_mfma_f32_16x16x32_bf16 v[84:87], a[84:87], v[200:203], v[84:87]
    ds_read_b64_tr_b16 a[254:255], v23 offset:4096
    v_cvt_pk_bf16_f32 v226, v228, v229
    v_mfma_f32_16x16x32_bf16 v[84:87], a[88:91], v[208:211], v[84:87]
    buffer_load_dwordx4 v11, s[56:59], s33 offen offset:3072  lds
    s_add_u32 m0, s37, 98304
    v_mfma_f32_16x16x32_bf16 v[84:87], a[92:95], v[216:219], v[84:87]
    ds_read_b64_tr_b16 a[0:1], v2 offset:32768
    s_waitcnt lgkmcnt(4)
    v_mfma_f32_16x16x32_bf16 v[232:235], a[232:235], a[184:187], 0
    ds_read_b64_tr_b16 a[2:3], v2 offset:34816
    s_xor_b32 s33, s32, 0
    v_mfma_f32_16x16x32_bf16 v[236:239], a[236:239], a[184:187], 0
    ds_read_b64_tr_b16 a[4:5], v2 offset:36864
    v_cvt_pk_bf16_f32 v227, v230, v231
    v_cvt_pk_bf16_f32 v228, v24, v25
    v_cvt_pk_bf16_f32 v229, v26, v27
    v_mfma_f32_16x16x32_bf16 v[24:27], a[232:235], a[188:191], 0
    buffer_load_dwordx4 v8, s[56:59], s33 offen offset:0  lds
    v_cvt_pk_bf16_f32 v230, v28, v29
    v_cvt_pk_bf16_f32 v231, v30, v31
    v_mfma_f32_16x16x32_bf16 v[28:31], a[236:239], a[188:191], 0
    ds_read_b64_tr_b16 a[6:7], v2 offset:38912
    ds_read_b64_tr_b16 a[8:9], v2 offset:40960
    v_mfma_f32_16x16x32_bf16 v[92:95], a[80:83], v[196:199], v[92:95]
    ds_read_b64_tr_b16 a[10:11], v2 offset:43008
    ds_read_b64_tr_b16 a[12:13], v2 offset:45056
    v_mfma_f32_16x16x32_bf16 v[92:95], a[84:87], v[204:207], v[92:95]
    ds_read_b64_tr_b16 a[14:15], v2 offset:47104
    v_cvt_pk_bf16_f32 v232, v232, v233
    v_mfma_f32_16x16x32_bf16 v[92:95], a[88:91], v[212:215], v[92:95]
    buffer_load_dwordx4 v9, s[56:59], s33 offen offset:1024  lds
    v_cvt_pk_bf16_f32 v233, v234, v235
    v_mfma_f32_16x16x32_bf16 v[92:95], a[92:95], v[220:223], v[92:95]
    ds_read_b64_tr_b16 a[16:17], v3 offset:32768
    v_cvt_pk_bf16_f32 v234, v236, v237
    v_mfma_f32_16x16x32_bf16 v[64:67], a[96:99], v[192:195], v[64:67]
    ds_read_b64_tr_b16 a[18:19], v3 offset:34816
    v_cvt_pk_bf16_f32 v235, v238, v239
    v_mfma_f32_16x16x32_bf16 v[64:67], a[100:103], v[200:203], v[64:67]
    ds_read_b64_tr_b16 a[20:21], v3 offset:36864
    v_cvt_pk_bf16_f32 v236, v24, v25
    v_mfma_f32_16x16x32_bf16 v[240:243], a[240:243], a[184:187], 0
    buffer_load_dwordx4 v10, s[56:59], s33 offen offset:2048  lds
    v_cvt_pk_bf16_f32 v237, v26, v27
    v_mfma_f32_16x16x32_bf16 v[244:247], a[244:247], a[184:187], 0
    ds_read_b64_tr_b16 a[22:23], v3 offset:38912
    v_cvt_pk_bf16_f32 v238, v28, v29
    v_mfma_f32_16x16x32_bf16 v[24:27], a[240:243], a[188:191], 0
    ds_read_b64_tr_b16 a[24:25], v3 offset:40960
    v_cvt_pk_bf16_f32 v239, v30, v31
    v_mfma_f32_16x16x32_bf16 v[28:31], a[244:247], a[188:191], 0
    ds_read_b64_tr_b16 a[26:27], v3 offset:43008
    ds_read_b64_tr_b16 a[28:29], v3 offset:45056
    v_mfma_f32_16x16x32_bf16 v[64:67], a[104:107], v[208:211], v[64:67]
    buffer_load_dwordx4 v11, s[56:59], s33 offen offset:3072  lds
    s_add_u32 m0, s37, 114688
    v_mfma_f32_16x16x32_bf16 v[64:67], a[108:111], v[216:219], v[64:67]
    ds_read_b64_tr_b16 a[30:31], v3 offset:47104
    s_xor_b32 s33, s32, 131072
    v_mfma_f32_16x16x32_bf16 v[72:75], a[96:99], v[196:199], v[72:75]
    ds_read_b64_tr_b16 a[32:33], v0 offset:32768
    v_cvt_pk_bf16_f32 v240, v240, v241
    v_mfma_f32_16x16x32_bf16 v[72:75], a[100:103], v[204:207], v[72:75]
    ds_read_b64_tr_b16 a[34:35], v0 offset:34816
    v_cvt_pk_bf16_f32 v241, v242, v243
    v_mfma_f32_16x16x32_bf16 v[72:75], a[104:107], v[212:215], v[72:75]
    buffer_load_dwordx4 v8, s[56:59], s33 offen offset:0  lds
    v_cvt_pk_bf16_f32 v242, v244, v245
    v_mfma_f32_16x16x32_bf16 v[72:75], a[108:111], v[220:223], v[72:75]
    ds_read_b64_tr_b16 a[36:37], v0 offset:36864
    s_waitcnt lgkmcnt(4)
    v_mfma_f32_16x16x32_bf16 v[248:251], a[248:251], a[184:187], 0
    ds_read_b64_tr_b16 a[38:39], v0 offset:38912
    v_cvt_pk_bf16_f32 v243, v246, v247
    v_mfma_f32_16x16x32_bf16 v[252:255], a[252:255], a[184:187], 0
    ds_read_b64_tr_b16 a[40:41], v0 offset:40960
    v_cvt_pk_bf16_f32 v244, v24, v25
    v_cvt_pk_bf16_f32 v245, v26, v27
    v_mfma_f32_16x16x32_bf16 v[24:27], a[248:251], a[188:191], 0
    buffer_load_dwordx4 v9, s[56:59], s33 offen offset:1024  lds
    v_cvt_pk_bf16_f32 v246, v28, v29
    v_cvt_pk_bf16_f32 v247, v30, v31
    v_mfma_f32_16x16x32_bf16 v[28:31], a[252:255], a[188:191], 0
    ds_read_b64_tr_b16 a[42:43], v0 offset:43008
    ds_read_b64_tr_b16 a[44:45], v0 offset:45056
    v_mfma_f32_16x16x32_bf16 v[68:71], a[112:115], v[192:195], v[68:71]
    ds_read_b64_tr_b16 a[46:47], v0 offset:47104
    ds_read_b64_tr_b16 a[48:49], v1 offset:32768
    v_mfma_f32_16x16x32_bf16 v[68:71], a[116:119], v[200:203], v[68:71]
    ds_read_b64_tr_b16 a[50:51], v1 offset:34816
    v_cvt_pk_bf16_f32 v248, v248, v249
    v_mfma_f32_16x16x32_bf16 v[68:71], a[120:123], v[208:211], v[68:71]
    buffer_load_dwordx4 v10, s[56:59], s33 offen offset:2048  lds
    v_cvt_pk_bf16_f32 v249, v250, v251
    v_mfma_f32_16x16x32_bf16 v[68:71], a[124:127], v[216:219], v[68:71]
    ds_read_b64_tr_b16 a[52:53], v1 offset:36864
    ds_read_b64_tr_b16 a[54:55], v1 offset:38912
    v_mfma_f32_16x16x32_bf16 v[76:79], a[112:115], v[196:199], v[76:79]
    ds_read_b64_tr_b16 a[56:57], v1 offset:40960
    ds_read_b64_tr_b16 a[58:59], v1 offset:43008
    v_mfma_f32_16x16x32_bf16 v[76:79], a[116:119], v[204:207], v[76:79]
    ds_read_b64_tr_b16 a[60:61], v1 offset:45056
    v_cvt_pk_bf16_f32 v250, v252, v253
    v_mfma_f32_16x16x32_bf16 v[76:79], a[120:123], v[212:215], v[76:79]
    buffer_load_dwordx4 v11, s[56:59], s33 offen offset:3072  lds
    v_cvt_pk_bf16_f32 v251, v254, v255
    v_mfma_f32_16x16x32_bf16 v[76:79], a[124:127], v[220:223], v[76:79]
    ds_read_b64_tr_b16 a[62:63], v1 offset:47104
    v_cvt_pk_bf16_f32 v252, v24, v25
    v_cvt_pk_bf16_f32 v253, v26, v27
    v_cvt_pk_bf16_f32 v254, v28, v29
    v_cvt_pk_bf16_f32 v255, v30, v31
    s_waitcnt vmcnt(16)
    s_barrier
    v_mfma_f32_16x16x32_bf16 v[80:83], a[0:3], v[224:227], v[80:83]
    ds_read_b64_tr_b16 a[64:65], v2 offset:0
    s_add_u32 m0, s37, 131072
    v_mfma_f32_16x16x32_bf16 v[80:83], a[4:7], v[232:235], v[80:83]
    ds_read_b64_tr_b16 a[66:67], v2 offset:2048
    s_xor_b32 s33, s32, 262144
    v_mfma_f32_16x16x32_bf16 v[80:83], a[8:11], v[240:243], v[80:83]
    buffer_load_dwordx4 v8, s[56:59], s33 offen offset:0  lds
    v_mfma_f32_16x16x32_bf16 v[80:83], a[12:15], v[248:251], v[80:83]
    ds_read_b64_tr_b16 a[68:69], v2 offset:4096
    ds_read_b64_tr_b16 a[70:71], v2 offset:6144
    v_mfma_f32_16x16x32_bf16 v[88:91], a[0:3], v[228:231], v[88:91]
    ds_read_b64_tr_b16 a[72:73], v2 offset:8192
    ds_read_b64_tr_b16 a[74:75], v2 offset:10240
    v_mfma_f32_16x16x32_bf16 v[88:91], a[4:7], v[236:239], v[88:91]
    ds_read_b64_tr_b16 a[76:77], v2 offset:12288
    ds_read_b64_tr_b16 a[78:79], v2 offset:14336
    v_mfma_f32_16x16x32_bf16 v[88:91], a[8:11], v[244:247], v[88:91]
    buffer_load_dwordx4 v9, s[56:59], s33 offen offset:1024  lds
    v_mfma_f32_16x16x32_bf16 v[88:91], a[12:15], v[252:255], v[88:91]
    ds_read_b64_tr_b16 a[80:81], v3 offset:0
    ds_read_b64_tr_b16 a[82:83], v3 offset:2048
    v_mfma_f32_16x16x32_bf16 v[84:87], a[16:19], v[224:227], v[84:87]
    ds_read_b64_tr_b16 a[84:85], v3 offset:4096
    ds_read_b64_tr_b16 a[86:87], v3 offset:6144
    v_mfma_f32_16x16x32_bf16 v[84:87], a[20:23], v[232:235], v[84:87]
    ds_read_b64_tr_b16 a[88:89], v3 offset:8192
    ds_read_b64_tr_b16 a[90:91], v3 offset:10240
    v_mfma_f32_16x16x32_bf16 v[84:87], a[24:27], v[240:243], v[84:87]
    buffer_load_dwordx4 v10, s[56:59], s33 offen offset:2048  lds
    s_waitcnt lgkmcnt(8)
    v_mfma_f32_16x16x32_bf16 v[84:87], a[28:31], v[248:251], v[84:87]
    ds_read_b64_tr_b16 a[92:93], v3 offset:12288
    v_mfma_f32_16x16x32_bf16 v[92:95], a[16:19], v[228:231], v[92:95]
    ds_read_b64_tr_b16 a[94:95], v3 offset:14336
    v_mfma_f32_16x16x32_bf16 v[92:95], a[20:23], v[236:239], v[92:95]
    ds_read_b64_tr_b16 a[96:97], v0 offset:0
    v_mfma_f32_16x16x32_bf16 v[92:95], a[24:27], v[244:247], v[92:95]
    buffer_load_dwordx4 v11, s[56:59], s33 offen offset:3072  lds
    v_mfma_f32_16x16x32_bf16 v[92:95], a[28:31], v[252:255], v[92:95]
    ds_read_b64_tr_b16 a[98:99], v0 offset:2048
    v_mfma_f32_16x16x32_bf16 v[64:67], a[32:35], v[224:227], v[64:67]
    ds_read_b64_tr_b16 a[100:101], v0 offset:4096
    s_xor_b32 s39, s17, 221184
    v_mfma_f32_16x16x32_bf16 v[64:67], a[36:39], v[232:235], v[64:67]
    ds_read_b64_tr_b16 a[102:103], v0 offset:6144
    v_mfma_f32_16x16x32_bf16 v[64:67], a[40:43], v[240:243], v[64:67]
    ds_read_b64_tr_b16 a[104:105], v0 offset:8192
    v_mfma_f32_16x16x32_bf16 v[64:67], a[44:47], v[248:251], v[64:67]
    ds_read_b64_tr_b16 a[106:107], v0 offset:10240
    v_cvt_pk_bf16_f32 v80, v80, v81
    v_mfma_f32_16x16x32_bf16 v[72:75], a[32:35], v[228:231], v[72:75]
    ds_read_b64_tr_b16 a[108:109], v0 offset:12288
    v_cvt_pk_bf16_f32 v81, v82, v83
    v_mfma_f32_16x16x32_bf16 v[72:75], a[36:39], v[236:239], v[72:75]
    ds_read_b64_tr_b16 a[110:111], v0 offset:14336
    v_cvt_pk_bf16_f32 v82, v84, v85
    v_mfma_f32_16x16x32_bf16 v[72:75], a[40:43], v[244:247], v[72:75]
    ds_read_b64_tr_b16 a[112:113], v1 offset:0
    v_cvt_pk_bf16_f32 v83, v86, v87
    v_mfma_f32_16x16x32_bf16 v[72:75], a[44:47], v[252:255], v[72:75]
    buffer_store_dwordx4 v[80:83], v14, s[60:63], s39 offen offset:0 sc1
    ds_read_b64_tr_b16 a[114:115], v1 offset:2048
    ds_read_b64_tr_b16 a[116:117], v1 offset:4096
    v_mfma_f32_16x16x32_bf16 v[68:71], a[48:51], v[224:227], v[68:71]
    ds_read_b64_tr_b16 a[118:119], v1 offset:6144
    v_cvt_pk_bf16_f32 v88, v88, v89
    v_mfma_f32_16x16x32_bf16 v[68:71], a[52:55], v[232:235], v[68:71]
    ds_read_b64_tr_b16 a[120:121], v1 offset:8192
    v_cvt_pk_bf16_f32 v89, v90, v91
    v_mfma_f32_16x16x32_bf16 v[68:71], a[56:59], v[240:243], v[68:71]
    ds_read_b64_tr_b16 a[122:123], v1 offset:10240
    v_cvt_pk_bf16_f32 v90, v92, v93
    v_mfma_f32_16x16x32_bf16 v[68:71], a[60:63], v[248:251], v[68:71]
    ds_read_b64_tr_b16 a[124:125], v1 offset:12288
    v_cvt_pk_bf16_f32 v91, v94, v95
    v_mfma_f32_16x16x32_bf16 v[76:79], a[48:51], v[228:231], v[76:79]
    buffer_store_dwordx4 v[88:91], v14, s[60:63], s39 offen offset:1024 sc1
    ds_read_b64_tr_b16 a[126:127], v1 offset:14336
    v_mfma_f32_16x16x32_bf16 v[76:79], a[52:55], v[236:239], v[76:79]
    v_mfma_f32_16x16x32_bf16 v[76:79], a[56:59], v[244:247], v[76:79]
    v_mfma_f32_16x16x32_bf16 v[76:79], a[60:63], v[252:255], v[76:79]
    v_mfma_f32_16x16x32_bf16 v[112:115], a[64:67], v[192:195], v[112:115]
    ds_read_b64_tr_b16 a[0:1], v2 offset:49152
    s_xor_b32 s39, s17, 147456
    v_mfma_f32_16x16x32_bf16 v[112:115], a[68:71], v[200:203], v[112:115]
    ds_read_b64_tr_b16 a[2:3], v2 offset:51200
    ds_read_b64_tr_b16 a[4:5], v2 offset:53248
    v_mfma_f32_16x16x32_bf16 v[112:115], a[72:75], v[208:211], v[112:115]
    ds_read_b64_tr_b16 a[6:7], v2 offset:55296
    s_waitcnt lgkmcnt(4)
    v_mfma_f32_16x16x32_bf16 v[112:115], a[76:79], v[216:219], v[112:115]
    ds_read_b64_tr_b16 a[8:9], v2 offset:57344
    v_cvt_pk_bf16_f32 v64, v64, v65
    v_mfma_f32_16x16x32_bf16 v[120:123], a[64:67], v[196:199], v[120:123]
    ds_read_b64_tr_b16 a[10:11], v2 offset:59392
    v_cvt_pk_bf16_f32 v65, v66, v67
    v_mfma_f32_16x16x32_bf16 v[120:123], a[68:71], v[204:207], v[120:123]
    ds_read_b64_tr_b16 a[12:13], v2 offset:61440
    v_cvt_pk_bf16_f32 v66, v68, v69
    v_mfma_f32_16x16x32_bf16 v[120:123], a[72:75], v[212:215], v[120:123]
    ds_read_b64_tr_b16 a[14:15], v2 offset:63488
    v_cvt_pk_bf16_f32 v67, v70, v71
    v_mfma_f32_16x16x32_bf16 v[120:123], a[76:79], v[220:223], v[120:123]
    buffer_store_dwordx4 v[64:67], v14, s[60:63], s39 offen offset:0 sc1
    ds_read_b64_tr_b16 a[16:17], v3 offset:49152
    ds_read_b64_tr_b16 a[18:19], v3 offset:51200
    v_mfma_f32_16x16x32_bf16 v[116:119], a[80:83], v[192:195], v[116:119]
    ds_read_b64_tr_b16 a[20:21], v3 offset:53248
    v_cvt_pk_bf16_f32 v72, v72, v73
    v_mfma_f32_16x16x32_bf16 v[116:119], a[84:87], v[200:203], v[116:119]
    ds_read_b64_tr_b16 a[22:23], v3 offset:55296
    v_cvt_pk_bf16_f32 v73, v74, v75
    v_mfma_f32_16x16x32_bf16 v[116:119], a[88:91], v[208:211], v[116:119]
    ds_read_b64_tr_b16 a[24:25], v3 offset:57344
    v_cvt_pk_bf16_f32 v74, v76, v77
    v_mfma_f32_16x16x32_bf16 v[116:119], a[92:95], v[216:219], v[116:119]
    ds_read_b64_tr_b16 a[26:27], v3 offset:59392
    v_cvt_pk_bf16_f32 v75, v78, v79
    v_mfma_f32_16x16x32_bf16 v[124:127], a[80:83], v[196:199], v[124:127]
    buffer_store_dwordx4 v[72:75], v14, s[60:63], s39 offen offset:1024 sc1
    ds_read_b64_tr_b16 a[28:29], v3 offset:61440
    ds_read_b64_tr_b16 a[30:31], v3 offset:63488
    v_mfma_f32_16x16x32_bf16 v[124:127], a[84:87], v[204:207], v[124:127]
    ds_read_b64_tr_b16 a[32:33], v0 offset:49152
    v_mfma_f32_16x16x32_bf16 v[124:127], a[88:91], v[212:215], v[124:127]
    ds_read_b64_tr_b16 a[34:35], v0 offset:51200
    v_mfma_f32_16x16x32_bf16 v[124:127], a[92:95], v[220:223], v[124:127]
    ds_read_b64_tr_b16 a[36:37], v0 offset:53248
    v_mfma_f32_16x16x32_bf16 v[96:99], a[96:99], v[192:195], v[96:99]
    ds_read_b64_tr_b16 a[38:39], v0 offset:55296
    v_mfma_f32_16x16x32_bf16 v[96:99], a[100:103], v[200:203], v[96:99]
    ds_read_b64_tr_b16 a[40:41], v0 offset:57344
    v_mfma_f32_16x16x32_bf16 v[96:99], a[104:107], v[208:211], v[96:99]
    ds_read_b64_tr_b16 a[42:43], v0 offset:59392
    v_mfma_f32_16x16x32_bf16 v[96:99], a[108:111], v[216:219], v[96:99]
    ds_read_b64_tr_b16 a[44:45], v0 offset:61440
    v_mfma_f32_16x16x32_bf16 v[104:107], a[96:99], v[196:199], v[104:107]
    ds_read_b64_tr_b16 a[46:47], v0 offset:63488
    v_mfma_f32_16x16x32_bf16 v[104:107], a[100:103], v[204:207], v[104:107]
    ds_read_b64_tr_b16 a[48:49], v1 offset:49152
    v_mfma_f32_16x16x32_bf16 v[104:107], a[104:107], v[212:215], v[104:107]
    ds_read_b64_tr_b16 a[50:51], v1 offset:51200
    v_mfma_f32_16x16x32_bf16 v[104:107], a[108:111], v[220:223], v[104:107]
    ds_read_b64_tr_b16 a[52:53], v1 offset:53248
    v_mfma_f32_16x16x32_bf16 v[100:103], a[112:115], v[192:195], v[100:103]
    ds_read_b64_tr_b16 a[54:55], v1 offset:55296
    v_mfma_f32_16x16x32_bf16 v[100:103], a[116:119], v[200:203], v[100:103]
    ds_read_b64_tr_b16 a[56:57], v1 offset:57344
    v_mfma_f32_16x16x32_bf16 v[100:103], a[120:123], v[208:211], v[100:103]
    ds_read_b64_tr_b16 a[58:59], v1 offset:59392
    v_mfma_f32_16x16x32_bf16 v[100:103], a[124:127], v[216:219], v[100:103]
    ds_read_b64_tr_b16 a[60:61], v1 offset:61440
    v_mfma_f32_16x16x32_bf16 v[108:111], a[112:115], v[196:199], v[108:111]
    ds_read_b64_tr_b16 a[62:63], v1 offset:63488
    v_mfma_f32_16x16x32_bf16 v[108:111], a[116:119], v[204:207], v[108:111]
    v_mfma_f32_16x16x32_bf16 v[108:111], a[120:123], v[212:215], v[108:111]
    v_mfma_f32_16x16x32_bf16 v[108:111], a[124:127], v[220:223], v[108:111]
    s_waitcnt vmcnt(20)
    s_barrier
    s_waitcnt lgkmcnt(4)
    v_mfma_f32_16x16x32_bf16 v[112:115], a[0:3], v[224:227], v[112:115]
    ds_read_b64_tr_b16 a[64:65], v6 offset:49152
    s_add_u32 m0, s37, 0
    v_mfma_f32_16x16x32_bf16 v[112:115], a[4:7], v[232:235], v[112:115]
    ds_read_b64_tr_b16 a[66:67], v6 offset:51200
    s_xor_b32 s33, s32, 393216
    v_mfma_f32_16x16x32_bf16 v[112:115], a[8:11], v[240:243], v[112:115]
    buffer_load_dwordx4 v8, s[56:59], s33 offen offset:0  lds
    v_mfma_f32_16x16x32_bf16 v[112:115], a[12:15], v[248:251], v[112:115]
    ds_read_b64_tr_b16 a[68:69], v6 offset:53248
    ds_read_b64_tr_b16 a[70:71], v6 offset:55296
    v_mfma_f32_16x16x32_bf16 v[120:123], a[0:3], v[228:231], v[120:123]
    ds_read_b64_tr_b16 a[72:73], v6 offset:57344
    ds_read_b64_tr_b16 a[74:75], v6 offset:59392
    v_mfma_f32_16x16x32_bf16 v[120:123], a[4:7], v[236:239], v[120:123]
    ds_read_b64_tr_b16 a[76:77], v6 offset:61440
    ds_read_b64_tr_b16 a[78:79], v6 offset:63488
    v_mfma_f32_16x16x32_bf16 v[120:123], a[8:11], v[244:247], v[120:123]
    buffer_load_dwordx4 v9, s[56:59], s33 offen offset:1024  lds
    v_mfma_f32_16x16x32_bf16 v[120:123], a[12:15], v[252:255], v[120:123]
    ds_read_b64_tr_b16 a[80:81], v7 offset:49152
    ds_read_b64_tr_b16 a[82:83], v7 offset:51200
    v_mfma_f32_16x16x32_bf16 v[116:119], a[16:19], v[224:227], v[116:119]
    ds_read_b64_tr_b16 a[84:85], v7 offset:53248
    ds_read_b64_tr_b16 a[86:87], v7 offset:55296
    v_mfma_f32_16x16x32_bf16 v[116:119], a[20:23], v[232:235], v[116:119]
    ds_read_b64_tr_b16 a[88:89], v7 offset:57344
    s_waitcnt vmcnt(2)
    v_mfma_f32_16x16x32_bf16 v[116:119], a[24:27], v[240:243], v[116:119]
    buffer_load_dwordx4 v10, s[56:59], s33 offen offset:2048  lds
    s_xor_b32 s11, s12, 1024
    v_mfma_f32_16x16x32_bf16 v[116:119], a[28:31], v[248:251], v[116:119]
    ds_read_b64_tr_b16 a[90:91], v7 offset:59392
    ds_read_b64_tr_b16 a[92:93], v7 offset:61440
    v_mfma_f32_16x16x32_bf16 v[124:127], a[16:19], v[228:231], v[124:127]
    s_atomic_add s20, s[8:9], s11
    s_xor_b32 s11, s12, 1536
    v_mfma_f32_16x16x32_bf16 v[124:127], a[20:23], v[236:239], v[124:127]
    s_atomic_add s20, s[8:9], s11
    ds_read_b64_tr_b16 a[94:95], v7 offset:63488
    v_mfma_f32_16x16x32_bf16 v[124:127], a[24:27], v[244:247], v[124:127]
    buffer_load_dwordx4 v11, s[56:59], s33 offen offset:3072  lds
    v_mfma_f32_16x16x32_bf16 v[124:127], a[28:31], v[252:255], v[124:127]
    ds_read_b64_tr_b16 a[96:97], v4 offset:49152
    ds_read_b64_tr_b16 a[98:99], v4 offset:51200
    v_mfma_f32_16x16x32_bf16 v[96:99], a[32:35], v[224:227], v[96:99]
    ds_read_b64_tr_b16 a[100:101], v4 offset:53248
    s_xor_b32 s64, s17, 368640
    v_mfma_f32_16x16x32_bf16 v[96:99], a[36:39], v[232:235], v[96:99]
    ds_read_b64_tr_b16 a[102:103], v4 offset:55296
    v_mfma_f32_16x16x32_bf16 v[96:99], a[40:43], v[240:243], v[96:99]
    ds_read_b64_tr_b16 a[104:105], v4 offset:57344
    v_mfma_f32_16x16x32_bf16 v[96:99], a[44:47], v[248:251], v[96:99]
    ds_read_b64_tr_b16 a[106:107], v4 offset:59392
    v_cvt_pk_bf16_f32 v112, v112, v113
    v_mfma_f32_16x16x32_bf16 v[104:107], a[32:35], v[228:231], v[104:107]
    ds_read_b64_tr_b16 a[108:109], v4 offset:61440
    v_cvt_pk_bf16_f32 v113, v114, v115
    v_mfma_f32_16x16x32_bf16 v[104:107], a[36:39], v[236:239], v[104:107]
    ds_read_b64_tr_b16 a[110:111], v4 offset:63488
    v_cvt_pk_bf16_f32 v114, v116, v117
    v_mfma_f32_16x16x32_bf16 v[104:107], a[40:43], v[244:247], v[104:107]
    ds_read_b64_tr_b16 a[112:113], v5 offset:49152
    v_cvt_pk_bf16_f32 v115, v118, v119
    v_mfma_f32_16x16x32_bf16 v[104:107], a[44:47], v[252:255], v[104:107]
    buffer_store_dwordx4 v[112:115], v14, s[60:63], s64 offen offset:0 sc1
    ds_read_b64_tr_b16 a[114:115], v5 offset:51200
    ds_read_b64_tr_b16 a[116:117], v5 offset:53248
    v_mfma_f32_16x16x32_bf16 v[100:103], a[48:51], v[224:227], v[100:103]
    ds_read_b64_tr_b16 a[118:119], v5 offset:55296
    v_cvt_pk_bf16_f32 v120, v120, v121
    v_mfma_f32_16x16x32_bf16 v[100:103], a[52:55], v[232:235], v[100:103]
    ds_read_b64_tr_b16 a[120:121], v5 offset:57344
    s_waitcnt lgkmcnt(7)
    v_mfma_f32_16x16x32_bf16 v[100:103], a[56:59], v[240:243], v[100:103]
    ds_read_b64_tr_b16 a[122:123], v5 offset:59392
    v_cvt_pk_bf16_f32 v121, v122, v123
    v_mfma_f32_16x16x32_bf16 v[100:103], a[60:63], v[248:251], v[100:103]
    ds_read_b64_tr_b16 a[124:125], v5 offset:61440
    v_cvt_pk_bf16_f32 v122, v124, v125
    v_mfma_f32_16x16x32_bf16 v[108:111], a[48:51], v[228:231], v[108:111]
    ds_read_b64_tr_b16 a[126:127], v5 offset:63488
    v_cvt_pk_bf16_f32 v123, v126, v127
    v_mfma_f32_16x16x32_bf16 v[108:111], a[52:55], v[236:239], v[108:111]
    buffer_store_dwordx4 v[120:123], v14, s[60:63], s64 offen offset:1024 sc1
    v_mfma_f32_16x16x32_bf16 v[108:111], a[56:59], v[244:247], v[108:111]
    v_mfma_f32_16x16x32_bf16 v[108:111], a[60:63], v[252:255], v[108:111]
    s_waitcnt vmcnt(2)
    s_barrier
    v_mfma_f32_16x16x32_bf16 v[48:51], a[64:67], v[192:195], v[48:51]
    ds_read_b64_tr_b16 a[0:1], v2 offset:16384
    s_xor_b32 s64, s17, 294912
    v_mfma_f32_16x16x32_bf16 v[48:51], a[68:71], v[200:203], v[48:51]
    ds_read_b64_tr_b16 a[2:3], v2 offset:18432
    ds_read_b64_tr_b16 a[4:5], v2 offset:20480
    v_mfma_f32_16x16x32_bf16 v[48:51], a[72:75], v[208:211], v[48:51]
    ds_read_b64_tr_b16 a[6:7], v2 offset:22528
    ds_read_b64_tr_b16 a[8:9], v2 offset:24576
    v_mfma_f32_16x16x32_bf16 v[48:51], a[76:79], v[216:219], v[48:51]
    ds_read_b64_tr_b16 a[10:11], v2 offset:26624
    v_cvt_pk_bf16_f32 v96, v96, v97
    v_mfma_f32_16x16x32_bf16 v[56:59], a[64:67], v[196:199], v[56:59]
    ds_read_b64_tr_b16 a[12:13], v2 offset:28672
    v_cvt_pk_bf16_f32 v97, v98, v99
    v_mfma_f32_16x16x32_bf16 v[56:59], a[68:71], v[204:207], v[56:59]
    ds_read_b64_tr_b16 a[14:15], v2 offset:30720
    v_cvt_pk_bf16_f32 v98, v100, v101
    v_mfma_f32_16x16x32_bf16 v[56:59], a[72:75], v[212:215], v[56:59]
    ds_read_b64_tr_b16 a[16:17], v3 offset:16384
    v_cvt_pk_bf16_f32 v99, v102, v103
    v_mfma_f32_16x16x32_bf16 v[56:59], a[76:79], v[220:223], v[56:59]
    buffer_store_dwordx4 v[96:99], v14, s[60:63], s64 offen offset:0 sc1
    ds_read_b64_tr_b16 a[18:19], v3 offset:18432
    ds_read_b64_tr_b16 a[20:21], v3 offset:20480
    v_mfma_f32_16x16x32_bf16 v[52:55], a[80:83], v[192:195], v[52:55]
    ds_read_b64_tr_b16 a[22:23], v3 offset:22528
    v_cvt_pk_bf16_f32 v104, v104, v105
    v_mfma_f32_16x16x32_bf16 v[52:55], a[84:87], v[200:203], v[52:55]
    ds_read_b64_tr_b16 a[24:25], v3 offset:24576
    v_cvt_pk_bf16_f32 v105, v106, v107
    v_mfma_f32_16x16x32_bf16 v[52:55], a[88:91], v[208:211], v[52:55]
    ds_read_b64_tr_b16 a[26:27], v3 offset:26624
    v_cvt_pk_bf16_f32 v106, v108, v109
    v_mfma_f32_16x16x32_bf16 v[52:55], a[92:95], v[216:219], v[52:55]
    ds_read_b64_tr_b16 a[28:29], v3 offset:28672
    v_cvt_pk_bf16_f32 v107, v110, v111
    v_mfma_f32_16x16x32_bf16 v[60:63], a[80:83], v[196:199], v[60:63]
    buffer_store_dwordx4 v[104:107], v14, s[60:63], s64 offen offset:1024 sc1
    s_load_dword s10, s[8:9], s12 glc
    ds_read_b64_tr_b16 a[30:31], v3 offset:30720
    v_mfma_f32_16x16x32_bf16 v[60:63], a[84:87], v[204:207], v[60:63]
    ds_read_b64_tr_b16 a[32:33], v0 offset:16384
    v_mfma_f32_16x16x32_bf16 v[60:63], a[88:91], v[212:215], v[60:63]
    ds_read_b64_tr_b16 a[34:35], v0 offset:18432
    v_mfma_f32_16x16x32_bf16 v[60:63], a[92:95], v[220:223], v[60:63]
    ds_read_b64_tr_b16 a[36:37], v0 offset:20480
    v_mfma_f32_16x16x32_bf16 v[32:35], a[96:99], v[192:195], v[32:35]
    ds_read_b64_tr_b16 a[38:39], v0 offset:22528
    v_mfma_f32_16x16x32_bf16 v[32:35], a[100:103], v[200:203], v[32:35]
    ds_read_b64_tr_b16 a[40:41], v0 offset:24576
    v_mfma_f32_16x16x32_bf16 v[32:35], a[104:107], v[208:211], v[32:35]
    ds_read_b64_tr_b16 a[42:43], v0 offset:26624
    s_waitcnt lgkmcnt(6)
    v_mfma_f32_16x16x32_bf16 v[32:35], a[108:111], v[216:219], v[32:35]
    ds_read_b64_tr_b16 a[44:45], v0 offset:28672
    v_mfma_f32_16x16x32_bf16 v[40:43], a[96:99], v[196:199], v[40:43]
    ds_read_b64_tr_b16 a[46:47], v0 offset:30720
    v_mfma_f32_16x16x32_bf16 v[40:43], a[100:103], v[204:207], v[40:43]
    ds_read_b64_tr_b16 a[48:49], v1 offset:16384
    v_mfma_f32_16x16x32_bf16 v[40:43], a[104:107], v[212:215], v[40:43]
    ds_read_b64_tr_b16 a[50:51], v1 offset:18432
    v_mfma_f32_16x16x32_bf16 v[40:43], a[108:111], v[220:223], v[40:43]
    ds_read_b64_tr_b16 a[52:53], v1 offset:20480
    v_mfma_f32_16x16x32_bf16 v[36:39], a[112:115], v[192:195], v[36:39]
    ds_read_b64_tr_b16 a[54:55], v1 offset:22528
    v_mfma_f32_16x16x32_bf16 v[36:39], a[116:119], v[200:203], v[36:39]
    ds_read_b64_tr_b16 a[56:57], v1 offset:24576
    v_mfma_f32_16x16x32_bf16 v[36:39], a[120:123], v[208:211], v[36:39]
    ds_read_b64_tr_b16 a[58:59], v1 offset:26624
    v_mfma_f32_16x16x32_bf16 v[36:39], a[124:127], v[216:219], v[36:39]
    ds_read_b64_tr_b16 a[60:61], v1 offset:28672
    v_mfma_f32_16x16x32_bf16 v[44:47], a[112:115], v[196:199], v[44:47]
    ds_read_b64_tr_b16 a[62:63], v1 offset:30720
    v_mfma_f32_16x16x32_bf16 v[44:47], a[116:119], v[204:207], v[44:47]
    v_mfma_f32_16x16x32_bf16 v[44:47], a[120:123], v[212:215], v[44:47]
    v_mfma_f32_16x16x32_bf16 v[44:47], a[124:127], v[220:223], v[44:47]
    v_mfma_f32_16x16x32_bf16 v[48:51], a[0:3], v[224:227], v[48:51]
    ds_read_b64_tr_b16 a[64:65], v6 offset:0
    ds_read_b64_tr_b16 a[66:67], v6 offset:2048
    v_mfma_f32_16x16x32_bf16 v[48:51], a[4:7], v[232:235], v[48:51]
    ds_read_b64_tr_b16 a[68:69], v6 offset:4096
    ds_read_b64_tr_b16 a[70:71], v6 offset:6144
    v_mfma_f32_16x16x32_bf16 v[48:51], a[8:11], v[240:243], v[48:51]
    ds_read_b64_tr_b16 a[72:73], v6 offset:8192
    v_mfma_f32_16x16x32_bf16 v[48:51], a[12:15], v[248:251], v[48:51]
    ds_read_b64_tr_b16 a[74:75], v6 offset:10240
    v_mfma_f32_16x16x32_bf16 v[56:59], a[0:3], v[228:231], v[56:59]
    ds_read_b64_tr_b16 a[76:77], v6 offset:12288
    v_mfma_f32_16x16x32_bf16 v[56:59], a[4:7], v[236:239], v[56:59]
    ds_read_b64_tr_b16 a[78:79], v6 offset:14336
    v_mfma_f32_16x16x32_bf16 v[56:59], a[8:11], v[244:247], v[56:59]
    ds_read_b64_tr_b16 a[80:81], v7 offset:0
    v_mfma_f32_16x16x32_bf16 v[56:59], a[12:15], v[252:255], v[56:59]
    ds_read_b64_tr_b16 a[82:83], v7 offset:2048
    v_mfma_f32_16x16x32_bf16 v[52:55], a[16:19], v[224:227], v[52:55]
    ds_read_b64_tr_b16 a[84:85], v7 offset:4096
    v_mfma_f32_16x16x32_bf16 v[52:55], a[20:23], v[232:235], v[52:55]
    ds_read_b64_tr_b16 a[86:87], v7 offset:6144
    v_mfma_f32_16x16x32_bf16 v[52:55], a[24:27], v[240:243], v[52:55]
    ds_read_b64_tr_b16 a[88:89], v7 offset:8192
    v_mfma_f32_16x16x32_bf16 v[52:55], a[28:31], v[248:251], v[52:55]
    ds_read_b64_tr_b16 a[90:91], v7 offset:10240
    v_mfma_f32_16x16x32_bf16 v[60:63], a[16:19], v[228:231], v[60:63]
    ds_read_b64_tr_b16 a[92:93], v7 offset:12288
    v_mfma_f32_16x16x32_bf16 v[60:63], a[20:23], v[236:239], v[60:63]
    ds_read_b64_tr_b16 a[94:95], v7 offset:14336
    v_mfma_f32_16x16x32_bf16 v[60:63], a[24:27], v[244:247], v[60:63]
    ds_read_b64_tr_b16 a[96:97], v6 offset:16384
    v_mfma_f32_16x16x32_bf16 v[60:63], a[28:31], v[252:255], v[60:63]
    ds_read_b64_tr_b16 a[98:99], v6 offset:18432
    s_waitcnt lgkmcnt(6)
    v_mfma_f32_16x16x32_bf16 v[32:35], a[32:35], v[224:227], v[32:35]
    ds_read_b64_tr_b16 a[100:101], v6 offset:20480
    s_xor_b32 s65, s17, 516096
    v_mfma_f32_16x16x32_bf16 v[32:35], a[36:39], v[232:235], v[32:35]
    ds_read_b64_tr_b16 a[102:103], v6 offset:22528
    v_mfma_f32_16x16x32_bf16 v[32:35], a[40:43], v[240:243], v[32:35]
    ds_read_b64_tr_b16 a[104:105], v6 offset:24576
    v_mfma_f32_16x16x32_bf16 v[32:35], a[44:47], v[248:251], v[32:35]
    ds_read_b64_tr_b16 a[106:107], v6 offset:26624
    v_cvt_pk_bf16_f32 v48, v48, v49
    v_mfma_f32_16x16x32_bf16 v[40:43], a[32:35], v[228:231], v[40:43]
    ds_read_b64_tr_b16 a[108:109], v6 offset:28672
    v_cvt_pk_bf16_f32 v49, v50, v51
    v_mfma_f32_16x16x32_bf16 v[40:43], a[36:39], v[236:239], v[40:43]
    ds_read_b64_tr_b16 a[110:111], v6 offset:30720
    v_cvt_pk_bf16_f32 v50, v52, v53
    v_mfma_f32_16x16x32_bf16 v[40:43], a[40:43], v[244:247], v[40:43]
    ds_read_b64_tr_b16 a[112:113], v7 offset:16384
    v_cvt_pk_bf16_f32 v51, v54, v55
    v_mfma_f32_16x16x32_bf16 v[40:43], a[44:47], v[252:255], v[40:43]
    buffer_store_dwordx4 v[48:51], v14, s[60:63], s65 offen offset:0 sc1
    ds_read_b64_tr_b16 a[114:115], v7 offset:18432
    ds_read_b64_tr_b16 a[116:117], v7 offset:20480
    v_mfma_f32_16x16x32_bf16 v[36:39], a[48:51], v[224:227], v[36:39]
    ds_read_b64_tr_b16 a[118:119], v7 offset:22528
    v_cvt_pk_bf16_f32 v56, v56, v57
    v_mfma_f32_16x16x32_bf16 v[36:39], a[52:55], v[232:235], v[36:39]
    ds_read_b64_tr_b16 a[120:121], v7 offset:24576
    v_cvt_pk_bf16_f32 v57, v58, v59
    v_mfma_f32_16x16x32_bf16 v[36:39], a[56:59], v[240:243], v[36:39]
    ds_read_b64_tr_b16 a[122:123], v7 offset:26624
    v_cvt_pk_bf16_f32 v58, v60, v61
    v_mfma_f32_16x16x32_bf16 v[36:39], a[60:63], v[248:251], v[36:39]
    ds_read_b64_tr_b16 a[124:125], v7 offset:28672
    v_cvt_pk_bf16_f32 v59, v62, v63
    v_mfma_f32_16x16x32_bf16 v[44:47], a[48:51], v[228:231], v[44:47]
    buffer_store_dwordx4 v[56:59], v14, s[60:63], s65 offen offset:1024 sc1
    ds_read_b64_tr_b16 a[126:127], v7 offset:30720
    v_mfma_f32_16x16x32_bf16 v[44:47], a[52:55], v[236:239], v[44:47]
    v_mfma_f32_16x16x32_bf16 v[44:47], a[56:59], v[244:247], v[44:47]
    v_mfma_f32_16x16x32_bf16 v[44:47], a[60:63], v[252:255], v[44:47]
    v_mfma_f32_16x16x32_bf16 v[80:83], a[64:67], v[128:131], 0
    ds_read_b64_tr_b16 a[0:1], v6 offset:32768
    s_bitcmp1_b32 s10, 1
    s_cbranch_scc0 L_cA
L_cA_ok:
    v_mfma_f32_16x16x32_bf16 v[80:83], a[68:71], v[136:139], v[80:83]
    ds_read_b64_tr_b16 a[2:3], v6 offset:34816
    s_add_u32 s100, s17, 16384
    v_mfma_f32_16x16x32_bf16 v[80:83], a[72:75], v[144:147], v[80:83]
    buffer_load_dwordx4 v[112:115], v14, s[60:63], s100 offen offset:0 sc1
    s_xor_b32 s65, s17, 442368
    v_mfma_f32_16x16x32_bf16 v[80:83], a[76:79], v[152:155], v[80:83]
    ds_read_b64_tr_b16 a[4:5], v6 offset:36864
    v_cvt_pk_bf16_f32 v32, v32, v33
    v_mfma_f32_16x16x32_bf16 v[88:91], a[64:67], v[132:135], 0
    ds_read_b64_tr_b16 a[6:7], v6 offset:38912
    v_cvt_pk_bf16_f32 v33, v34, v35
    v_mfma_f32_16x16x32_bf16 v[88:91], a[68:71], v[140:143], v[88:91]
    ds_read_b64_tr_b16 a[8:9], v6 offset:40960
    v_cvt_pk_bf16_f32 v34, v36, v37
    v_mfma_f32_16x16x32_bf16 v[88:91], a[72:75], v[148:151], v[88:91]
    buffer_load_dwordx4 v[116:119], v14, s[60:63], s100 offen offset:1024 sc1
    s_add_u32 s100, s17, 24576
    v_mfma_f32_16x16x32_bf16 v[88:91], a[76:79], v[156:159], v[88:91]
    ds_read_b64_tr_b16 a[10:11], v6 offset:43008
    v_cvt_pk_bf16_f32 v35, v38, v39
    v_mfma_f32_16x16x32_bf16 v[84:87], a[80:83], v[128:131], 0
    ds_read_b64_tr_b16 a[12:13], v6 offset:45056
    ds_read_b64_tr_b16 a[14:15], v6 offset:47104
    v_mfma_f32_16x16x32_bf16 v[84:87], a[84:87], v[136:139], v[84:87]
    ds_read_b64_tr_b16 a[16:17], v7 offset:32768
    s_waitcnt lgkmcnt(6)
    v_mfma_f32_16x16x32_bf16 v[84:87], a[88:91], v[144:147], v[84:87]
    buffer_load_dwordx4 v[120:123], v14, s[60:63], s100 offen offset:0 sc1
    v_mfma_f32_16x16x32_bf16 v[84:87], a[92:95], v[152:155], v[84:87]
    ds_read_b64_tr_b16 a[18:19], v7 offset:34816
    ds_read_b64_tr_b16 a[20:21], v7 offset:36864
    v_mfma_f32_16x16x32_bf16 v[92:95], a[80:83], v[132:135], 0
    ds_read_b64_tr_b16 a[22:23], v7 offset:38912
    ds_read_b64_tr_b16 a[24:25], v7 offset:40960
    v_mfma_f32_16x16x32_bf16 v[92:95], a[84:87], v[140:143], v[92:95]
    ds_read_b64_tr_b16 a[26:27], v7 offset:43008
    ds_read_b64_tr_b16 a[28:29], v7 offset:45056
    v_mfma_f32_16x16x32_bf16 v[92:95], a[88:91], v[148:151], v[92:95]
    buffer_load_dwordx4 v[124:127], v14, s[60:63], s100 offen offset:1024 sc1
    v_mfma_f32_16x16x32_bf16 v[92:95], a[92:95], v[156:159], v[92:95]
    ds_read_b64_tr_b16 a[30:31], v7 offset:47104
    ds_read_b64_tr_b16 a[32:33], v2 offset:0
    v_mfma_f32_16x16x32_bf16 v[80:83], a[96:99], v[160:163], v[80:83]
    ds_read_b64_tr_b16 a[34:35], v2 offset:2048
    ds_read_b64_tr_b16 a[36:37], v2 offset:4096
    v_mfma_f32_16x16x32_bf16 v[80:83], a[100:103], v[168:171], v[80:83]
    ds_read_b64_tr_b16 a[38:39], v2 offset:6144
    ds_read_b64_tr_b16 a[40:41], v2 offset:8192
    v_mfma_f32_16x16x32_bf16 v[80:83], a[104:107], v[176:179], v[80:83]
    buffer_store_dwordx4 v[32:35], v14, s[60:63], s65 offen offset:0 sc1
    ds_read_b64_tr_b16 a[42:43], v2 offset:10240
    ds_read_b64_tr_b16 a[44:45], v2 offset:12288
    v_cvt_pk_bf16_f32 v40, v40, v41
    v_mfma_f32_16x16x32_bf16 v[80:83], a[108:111], v[184:187], v[80:83]
    ds_read_b64_tr_b16 a[46:47], v2 offset:14336
    v_cvt_pk_bf16_f32 v41, v42, v43
    v_cvt_pk_bf16_f32 v42, v44, v45
    v_mfma_f32_16x16x32_bf16 v[88:91], a[96:99], v[164:167], v[88:91]
    ds_read_b64_tr_b16 a[48:49], v3 offset:0
    v_cvt_pk_bf16_f32 v43, v46, v47
    v_mfma_f32_16x16x32_bf16 v[88:91], a[100:103], v[172:175], v[88:91]
    ds_read_b64_tr_b16 a[50:51], v3 offset:2048
    s_waitcnt vmcnt(7)
    v_mfma_f32_16x16x32_bf16 v[88:91], a[104:107], v[180:183], v[88:91]
    buffer_store_dwordx4 v[40:43], v14, s[60:63], s65 offen offset:1024 sc1
    ds_read_b64_tr_b16 a[52:53], v3 offset:4096
    ds_read_b64_tr_b16 a[54:55], v3 offset:6144
    v_mfma_f32_16x16x32_bf16 v[88:91], a[108:111], v[188:191], v[88:91]
    ds_read_b64_tr_b16 a[56:57], v3 offset:8192
    s_xor_b32 s15, s12, 2048
    v_mfma_f32_16x16x32_bf16 v[84:87], a[112:115], v[160:163], v[84:87]
    s_atomic_add s21, s[8:9], s15
    s_xor_b32 s15, s12, 2560
    v_mfma_f32_16x16x32_bf16 v[84:87], a[116:119], v[168:171], v[84:87]
    s_atomic_add s21, s[8:9], s15
    v_mfma_f32_16x16x32_bf16 v[84:87], a[120:123], v[176:179], v[84:87]
    ds_read_b64_tr_b16 a[58:59], v3 offset:10240
    v_mfma_f32_16x16x32_bf16 v[84:87], a[124:127], v[184:187], v[84:87]
    ds_read_b64_tr_b16 a[60:61], v3 offset:12288
    v_mfma_f32_16x16x32_bf16 v[92:95], a[112:115], v[164:167], v[92:95]
    s_load_dword s10, s[8:9], s12 glc
    v_mfma_f32_16x16x32_bf16 v[92:95], a[116:119], v[172:175], v[92:95]
    ds_read_b64_tr_b16 a[62:63], v3 offset:14336
    v_mfma_f32_16x16x32_bf16 v[92:95], a[120:123], v[180:183], v[92:95]
    v_mfma_f32_16x16x32_bf16 v[92:95], a[124:127], v[188:191], v[92:95]
    v_mfma_f32_16x16x32_bf16 v[80:83], a[0:3], v[192:195], v[80:83]
    ds_read_b64_tr_b16 a[64:65], v4 offset:0
    s_waitcnt lgkmcnt(4)
    v_mfma_f32_16x16x32_bf16 v[80:83], a[4:7], v[200:203], v[80:83]
    ds_read_b64_tr_b16 a[66:67], v4 offset:2048
    v_mfma_f32_16x16x32_bf16 v[80:83], a[8:11], v[208:211], v[80:83]
    ds_read_b64_tr_b16 a[68:69], v4 offset:4096
    v_mfma_f32_16x16x32_bf16 v[80:83], a[12:15], v[216:219], v[80:83]
    ds_read_b64_tr_b16 a[70:71], v4 offset:6144
    v_mfma_f32_16x16x32_bf16 v[88:91], a[0:3], v[196:199], v[88:91]
    ds_read_b64_tr_b16 a[72:73], v4 offset:8192
    v_mfma_f32_16x16x32_bf16 v[88:91], a[4:7], v[204:207], v[88:91]
    ds_read_b64_tr_b16 a[74:75], v4 offset:10240
    v_mfma_f32_16x16x32_bf16 v[88:91], a[8:11], v[212:215], v[88:91]
    ds_read_b64_tr_b16 a[76:77], v4 offset:12288
    v_mfma_f32_16x16x32_bf16 v[88:91], a[12:15], v[220:223], v[88:91]
    ds_read_b64_tr_b16 a[78:79], v4 offset:14336
    v_mfma_f32_16x16x32_bf16 v[84:87], a[16:19], v[192:195], v[84:87]
    ds_read_b64_tr_b16 a[80:81], v5 offset:0
    v_mfma_f32_16x16x32_bf16 v[84:87], a[20:23], v[200:203], v[84:87]
    ds_read_b64_tr_b16 a[82:83], v5 offset:2048
    v_mfma_f32_16x16x32_bf16 v[84:87], a[24:27], v[208:211], v[84:87]
    ds_read_b64_tr_b16 a[84:85], v5 offset:4096
    v_mfma_f32_16x16x32_bf16 v[84:87], a[28:31], v[216:219], v[84:87]
    ds_read_b64_tr_b16 a[86:87], v5 offset:6144
    v_mfma_f32_16x16x32_bf16 v[92:95], a[16:19], v[196:199], v[92:95]
    ds_read_b64_tr_b16 a[88:89], v5 offset:8192
    v_mfma_f32_16x16x32_bf16 v[92:95], a[20:23], v[204:207], v[92:95]
    ds_read_b64_tr_b16 a[90:91], v5 offset:10240
    v_mfma_f32_16x16x32_bf16 v[92:95], a[24:27], v[212:215], v[92:95]
    ds_read_b64_tr_b16 a[92:93], v5 offset:12288
    v_mfma_f32_16x16x32_bf16 v[92:95], a[28:31], v[220:223], v[92:95]
    ds_read_b64_tr_b16 a[94:95], v5 offset:14336
    v_mfma_f32_16x16x32_bf16 v[80:83], a[32:35], v[224:227], v[80:83]
    ds_read_b64_tr_b16 a[96:97], v4 offset:16384
    v_mfma_f32_16x16x32_bf16 v[80:83], a[36:39], v[232:235], v[80:83]
    ds_read_b64_tr_b16 a[98:99], v4 offset:18432
    v_mfma_f32_16x16x32_bf16 v[80:83], a[40:43], v[240:243], v[80:83]
    ds_read_b64_tr_b16 a[100:101], v4 offset:20480
    v_mfma_f32_16x16x32_bf16 v[80:83], a[44:47], v[248:251], v[80:83]
    ds_read_b64_tr_b16 a[102:103], v4 offset:22528
    v_mfma_f32_16x16x32_bf16 v[88:91], a[32:35], v[228:231], v[88:91]
    ds_read_b64_tr_b16 a[104:105], v4 offset:24576
    v_mfma_f32_16x16x32_bf16 v[88:91], a[36:39], v[236:239], v[88:91]
    ds_read_b64_tr_b16 a[106:107], v4 offset:26624
    v_mfma_f32_16x16x32_bf16 v[88:91], a[40:43], v[244:247], v[88:91]
    ds_read_b64_tr_b16 a[108:109], v4 offset:28672
    v_mfma_f32_16x16x32_bf16 v[88:91], a[44:47], v[252:255], v[88:91]
    ds_read_b64_tr_b16 a[110:111], v4 offset:30720
    v_mfma_f32_16x16x32_bf16 v[84:87], a[48:51], v[224:227], v[84:87]
    ds_read_b64_tr_b16 a[112:113], v5 offset:16384
    v_mfma_f32_16x16x32_bf16 v[84:87], a[52:55], v[232:235], v[84:87]
    ds_read_b64_tr_b16 a[114:115], v5 offset:18432
    s_waitcnt lgkmcnt(6)
    v_mfma_f32_16x16x32_bf16 v[84:87], a[56:59], v[240:243], v[84:87]
    ds_read_b64_tr_b16 a[116:117], v5 offset:20480
    v_mfma_f32_16x16x32_bf16 v[84:87], a[60:63], v[248:251], v[84:87]
    ds_read_b64_tr_b16 a[118:119], v5 offset:22528
    v_mfma_f32_16x16x32_bf16 v[92:95], a[48:51], v[228:231], v[92:95]
    ds_read_b64_tr_b16 a[120:121], v5 offset:24576
    v_mfma_f32_16x16x32_bf16 v[92:95], a[52:55], v[236:239], v[92:95]
    ds_read_b64_tr_b16 a[122:123], v5 offset:26624
    v_mfma_f32_16x16x32_bf16 v[92:95], a[56:59], v[244:247], v[92:95]
    ds_read_b64_tr_b16 a[124:125], v5 offset:28672
    v_mfma_f32_16x16x32_bf16 v[92:95], a[60:63], v[252:255], v[92:95]
    ds_read_b64_tr_b16 a[126:127], v5 offset:30720
    v_mfma_f32_16x16x32_bf16 v[64:67], a[64:67], v[128:131], 0
    ds_read_b64_tr_b16 a[0:1], v4 offset:32768
    s_xor_b32 s39, s17, 73728
    v_mfma_f32_16x16x32_bf16 v[64:67], a[68:71], v[136:139], v[64:67]
    ds_read_b64_tr_b16 a[2:3], v4 offset:34816
    ds_read_b64_tr_b16 a[4:5], v4 offset:36864
    v_mfma_f32_16x16x32_bf16 v[64:67], a[72:75], v[144:147], v[64:67]
    ds_read_b64_tr_b16 a[6:7], v4 offset:38912
    ds_read_b64_tr_b16 a[8:9], v4 offset:40960
    v_mfma_f32_16x16x32_bf16 v[64:67], a[76:79], v[152:155], v[64:67]
    ds_read_b64_tr_b16 a[10:11], v4 offset:43008
    v_cvt_pk_bf16_f32 v80, v80, v81
    v_mfma_f32_16x16x32_bf16 v[72:75], a[64:67], v[132:135], 0
    ds_read_b64_tr_b16 a[12:13], v4 offset:45056
    v_cvt_pk_bf16_f32 v81, v82, v83
    v_mfma_f32_16x16x32_bf16 v[72:75], a[68:71], v[140:143], v[72:75]
    ds_read_b64_tr_b16 a[14:15], v4 offset:47104
    v_cvt_pk_bf16_f32 v82, v84, v85
    v_mfma_f32_16x16x32_bf16 v[72:75], a[72:75], v[148:151], v[72:75]
    ds_read_b64_tr_b16 a[16:17], v5 offset:32768
    v_cvt_pk_bf16_f32 v83, v86, v87
    v_mfma_f32_16x16x32_bf16 v[72:75], a[76:79], v[156:159], v[72:75]
    buffer_store_dwordx4 v[80:83], v14, s[60:63], s39 offen offset:0 sc1
    ds_read_b64_tr_b16 a[18:19], v5 offset:34816
    ds_read_b64_tr_b16 a[20:21], v5 offset:36864
    v_mfma_f32_16x16x32_bf16 v[68:71], a[80:83], v[128:131], 0
    ds_read_b64_tr_b16 a[22:23], v5 offset:38912
    v_cvt_pk_bf16_f32 v88, v88, v89
    v_mfma_f32_16x16x32_bf16 v[68:71], a[84:87], v[136:139], v[68:71]
    ds_read_b64_tr_b16 a[24:25], v5 offset:40960
    v_cvt_pk_bf16_f32 v89, v90, v91
    v_mfma_f32_16x16x32_bf16 v[68:71], a[88:91], v[144:147], v[68:71]
    ds_read_b64_tr_b16 a[26:27], v5 offset:43008
    v_cvt_pk_bf16_f32 v90, v92, v93
    v_mfma_f32_16x16x32_bf16 v[68:71], a[92:95], v[152:155], v[68:71]
    ds_read_b64_tr_b16 a[28:29], v5 offset:45056
    v_cvt_pk_bf16_f32 v91, v94, v95
    v_mfma_f32_16x16x32_bf16 v[76:79], a[80:83], v[132:135], 0
    buffer_store_dwordx4 v[88:91], v14, s[60:63], s39 offen offset:1024 sc1
    ds_read_b64_tr_b16 a[30:31], v5 offset:47104
    ds_read_b64_tr_b16 a[32:33], v0 offset:0
    v_mfma_f32_16x16x32_bf16 v[76:79], a[84:87], v[140:143], v[76:79]
    ds_read_b64_tr_b16 a[34:35], v0 offset:2048
    s_waitcnt vmcnt(2)
    v_mfma_f32_16x16x32_bf16 v[76:79], a[88:91], v[148:151], v[76:79]
    ds_read_b64_tr_b16 a[36:37], v0 offset:4096
    s_xor_b32 s29, s12, 3072
    v_mfma_f32_16x16x32_bf16 v[76:79], a[92:95], v[156:159], v[76:79]
    s_atomic_add s22, s[8:9], s29
    s_xor_b32 s29, s12, 3584
    v_mfma_f32_16x16x32_bf16 v[64:67], a[96:99], v[160:163], v[64:67]
    s_atomic_add s22, s[8:9], s29
    ds_read_b64_tr_b16 a[38:39], v0 offset:6144
    v_mfma_f32_16x16x32_bf16 v[64:67], a[100:103], v[168:171], v[64:67]
    ds_read_b64_tr_b16 a[40:41], v0 offset:8192
    s_waitcnt lgkmcnt(6)
    v_mfma_f32_16x16x32_bf16 v[64:67], a[104:107], v[176:179], v[64:67]
    ds_read_b64_tr_b16 a[42:43], v0 offset:10240
    s_waitcnt vmcnt(4)
    v_mfma_f32_16x16x32_bf16 v[64:67], a[108:111], v[184:187], v[64:67]
    ds_read_b64_tr_b16 a[44:45], v0 offset:12288
    ds_read_b64_tr_b16 a[46:47], v0 offset:14336
    v_mfma_f32_16x16x32_bf16 v[72:75], a[96:99], v[164:167], v[72:75]
    ds_read_b64_tr_b16 a[48:49], v1 offset:0
    v_lshlrev_b32 v96, 16, v112
    v_mfma_f32_16x16x32_bf16 v[72:75], a[100:103], v[172:175], v[72:75]
    ds_read_b64_tr_b16 a[50:51], v1 offset:2048
    v_and_b32 v97, 0xffff0000, v112
    v_mfma_f32_16x16x32_bf16 v[72:75], a[104:107], v[180:183], v[72:75]
    ds_read_b64_tr_b16 a[52:53], v1 offset:4096
    v_lshlrev_b32 v98, 16, v113
    v_mfma_f32_16x16x32_bf16 v[72:75], a[108:111], v[188:191], v[72:75]
    ds_read_b64_tr_b16 a[54:55], v1 offset:6144
    v_and_b32 v99, 0xffff0000, v113
    v_mfma_f32_16x16x32_bf16 v[68:71], a[112:115], v[160:163], v[68:71]
    ds_read_b64_tr_b16 a[56:57], v1 offset:8192
    v_lshlrev_b32 v100, 16, v114
    v_and_b32 v101, 0xffff0000, v114
    v_mfma_f32_16x16x32_bf16 v[68:71], a[116:119], v[168:171], v[68:71]
    ds_read_b64_tr_b16 a[58:59], v1 offset:10240
    v_lshlrev_b32 v102, 16, v115
    v_and_b32 v103, 0xffff0000, v115
    v_mfma_f32_16x16x32_bf16 v[68:71], a[120:123], v[176:179], v[68:71]
    ds_read_b64_tr_b16 a[60:61], v1 offset:12288
    v_lshlrev_b32 v104, 16, v116
    v_and_b32 v105, 0xffff0000, v116
    v_mfma_f32_16x16x32_bf16 v[68:71], a[124:127], v[184:187], v[68:71]
    ds_read_b64_tr_b16 a[62:63], v1 offset:14336
    v_lshlrev_b32 v106, 16, v117
    v_and_b32 v107, 0xffff0000, v117
    v_mfma_f32_16x16x32_bf16 v[76:79], a[112:115], v[164:167], v[76:79]
    ds_read_b32 a144, v0
    v_lshlrev_b32 v108, 16, v118
    v_and_b32 v109, 0xffff0000, v118
    v_mfma_f32_16x16x32_bf16 v[76:79], a[116:119], v[172:175], v[76:79]
    ds_read_b32 a145, v0
    v_lshlrev_b32 v110, 16, v119
    v_and_b32 v111, 0xffff0000, v119
    v_mfma_f32_16x16x32_bf16 v[76:79], a[120:123], v[180:183], v[76:79]
    ds_read_b32 a146, v0
    v_lshlrev_b32 v20, 16, v120
    v_and_b32 v120, 0xffff0000, v120
    v_mfma_f32_16x16x32_bf16 v[76:79], a[124:127], v[188:191], v[76:79]
    ds_read_b32 a147, v0
    v_add_f32 v96, v96, v20
    v_add_f32 v97, v97, v120
    v_lshlrev_b32 v20, 16, v121
    v_and_b32 v121, 0xffff0000, v121
    v_add_f32 v98, v98, v20
    v_add_f32 v99, v99, v121
    v_lshlrev_b32 v20, 16, v122
    v_and_b32 v122, 0xffff0000, v122
    v_add_f32 v100, v100, v20
    v_add_f32 v101, v101, v122
    v_lshlrev_b32 v20, 16, v123
    v_and_b32 v123, 0xffff0000, v123
    v_add_f32 v102, v102, v20
    v_add_f32 v103, v103, v123
    v_lshlrev_b32 v20, 16, v124
    v_and_b32 v124, 0xffff0000, v124
    v_add_f32 v104, v104, v20
    v_add_f32 v105, v105, v124
    v_lshlrev_b32 v20, 16, v125
    v_and_b32 v125, 0xffff0000, v125
    v_add_f32 v106, v106, v20
    v_add_f32 v107, v107, v125
    v_lshlrev_b32 v20, 16, v126
    v_and_b32 v126, 0xffff0000, v126
    v_add_f32 v108, v108, v20
    v_add_f32 v109, v109, v126
    v_lshlrev_b32 v20, 16, v127
    v_and_b32 v127, 0xffff0000, v127
    v_add_f32 v110, v110, v20
    v_add_f32 v111, v111, v127
    v_mfma_f32_16x16x32_bf16 v[64:67], a[0:3], v[192:195], v[64:67]
    v_mfma_f32_16x16x32_bf16 v[64:67], a[4:7], v[200:203], v[64:67]
    v_mfma_f32_16x16x32_bf16 v[64:67], a[8:11], v[208:211], v[64:67]
    v_mfma_f32_16x16x32_bf16 v[64:67], a[12:15], v[216:219], v[64:67]
    v_mfma_f32_16x16x32_bf16 v[72:75], a[0:3], v[196:199], v[72:75]
    v_mfma_f32_16x16x32_bf16 v[72:75], a[4:7], v[204:207], v[72:75]
    s_waitcnt vmcnt(0)
    s_xor_b32 s30, s12, 512
    v_mfma_f32_16x16x32_bf16 v[72:75], a[8:11], v[212:215], v[72:75]
    v_mfma_f32_16x16x32_bf16 v[72:75], a[12:15], v[220:223], v[72:75]
    v_mfma_f32_16x16x32_bf16 v[68:71], a[16:19], v[192:195], v[68:71]
    s_load_dword s10, s[8:9], s12 glc
    s_atomic_add s23, s[8:9], s30
    v_mfma_f32_16x16x32_bf16 v[68:71], a[20:23], v[200:203], v[68:71]
    v_mfma_f32_16x16x32_bf16 v[68:71], a[24:27], v[208:211], v[68:71]
    s_waitcnt lgkmcnt(4)
    v_mfma_f32_16x16x32_bf16 v[68:71], a[28:31], v[216:219], v[68:71]
    v_mfma_f32_16x16x32_bf16 v[76:79], a[16:19], v[196:199], v[76:79]
    v_mfma_f32_16x16x32_bf16 v[76:79], a[20:23], v[204:207], v[76:79]
    v_mfma_f32_16x16x32_bf16 v[76:79], a[24:27], v[212:215], v[76:79]
    v_mfma_f32_16x16x32_bf16 v[76:79], a[28:31], v[220:223], v[76:79]
    v_mfma_f32_16x16x32_bf16 v[64:67], a[32:35], v[224:227], v[64:67]
    v_mfma_f32_16x16x32_bf16 v[64:67], a[36:39], v[232:235], v[64:67]
    v_mfma_f32_16x16x32_bf16 v[64:67], a[40:43], v[240:243], v[64:67]
    v_mfma_f32_16x16x32_bf16 v[64:67], a[44:47], v[248:251], v[64:67]
    v_mfma_f32_16x16x32_bf16 v[72:75], a[32:35], v[228:231], v[72:75]
    v_mfma_f32_16x16x32_bf16 v[72:75], a[36:39], v[236:239], v[72:75]
    v_mfma_f32_16x16x32_bf16 v[72:75], a[40:43], v[244:247], v[72:75]
    v_mfma_f32_16x16x32_bf16 v[72:75], a[44:47], v[252:255], v[72:75]
    v_mfma_f32_16x16x32_bf16 v[68:71], a[48:51], v[224:227], v[68:71]
    v_mfma_f32_16x16x32_bf16 v[68:71], a[52:55], v[232:235], v[68:71]
    v_mfma_f32_16x16x32_bf16 v[68:71], a[56:59], v[240:243], v[68:71]
    v_mfma_f32_16x16x32_bf16 v[68:71], a[60:63], v[248:251], v[68:71]
    v_mfma_f32_16x16x32_bf16 v[76:79], a[48:51], v[228:231], v[76:79]
    v_mfma_f32_16x16x32_bf16 v[76:79], a[52:55], v[236:239], v[76:79]
    v_mfma_f32_16x16x32_bf16 v[76:79], a[56:59], v[244:247], v[76:79]
    v_mfma_f32_16x16x32_bf16 v[76:79], a[60:63], v[252:255], v[76:79]
    s_nop 3
    v_pk_add_f32 v[96:97], v[96:97], v[64:65]
    v_pk_add_f32 v[98:99], v[98:99], v[66:67]
    v_pk_add_f32 v[100:101], v[100:101], v[68:69]
    v_pk_add_f32 v[102:103], v[102:103], v[70:71]
    v_pk_add_f32 v[104:105], v[104:105], v[72:73]
    v_pk_add_f32 v[106:107], v[106:107], v[74:75]
    v_pk_add_f32 v[108:109], v[108:109], v[76:77]
    v_pk_add_f32 v[110:111], v[110:111], v[78:79]
    s_bitcmp1_b32 s10, 5
    s_cbranch_scc0 L_cB
L_cB_ok:
    s_add_u32 s100, s17, 32768
    buffer_load_dwordx4 v[32:35], v14, s[60:63], s100 offen offset:0 sc1
    buffer_load_dwordx4 v[36:39], v14, s[60:63], s100 offen offset:1024 sc1
    s_add_u32 s100, s17, 40960
    buffer_load_dwordx4 v[40:43], v14, s[60:63], s100 offen offset:0 sc1
    buffer_load_dwordx4 v[44:47], v14, s[60:63], s100 offen offset:1024 sc1
    s_bitcmp1_b32 s10, 9
    s_cbranch_scc0 L_cC
L_cC_ok:
    s_add_u32 s100, s17, 49152
    buffer_load_dwordx4 v[128:131], v14, s[60:63], s100 offen offset:0 sc1
    buffer_load_dwordx4 v[132:135], v14, s[60:63], s100 offen offset:1024 sc1
    s_add_u32 s100, s17, 57344
    buffer_load_dwordx4 v[136:139], v14, s[60:63], s100 offen offset:0 sc1
    buffer_load_dwordx4 v[140:143], v14, s[60:63], s100 offen offset:1024 sc1
    s_bitcmp1_b32 s10, 12
    s_cbranch_scc0 L_cD
L_cD_ok:
    s_add_u32 s100, s17, 8192
    buffer_load_dwordx4 v[144:147], v14, s[60:63], s100 offen offset:0 sc1
    buffer_load_dwordx4 v[148:151], v14, s[60:63], s100 offen offset:1024 sc1
    s_waitcnt vmcnt(6)
    v_lshlrev_b32 v16, 16, v32
    v_and_b32 v17, 0xffff0000, v32
    v_pk_add_f32 v[96:97], v[96:97], v[16:17]
    v_lshlrev_b32 v18, 16, v33
    v_and_b32 v19, 0xffff0000, v33
    v_pk_add_f32 v[98:99], v[98:99], v[18:19]
    v_lshlrev_b32 v16, 16, v34
    v_and_b32 v17, 0xffff0000, v34
    v_pk_add_f32 v[100:101], v[100:101], v[16:17]
    v_lshlrev_b32 v18, 16, v35
    v_and_b32 v19, 0xffff0000, v35
    v_pk_add_f32 v[102:103], v[102:103], v[18:19]
    v_lshlrev_b32 v16, 16, v36
    v_and_b32 v17, 0xffff0000, v36
    v_pk_add_f32 v[104:105], v[104:105], v[16:17]
    v_lshlrev_b32 v18, 16, v37
    v_and_b32 v19, 0xffff0000, v37
    v_pk_add_f32 v[106:107], v[106:107], v[18:19]
    v_lshlrev_b32 v16, 16, v38
    v_and_b32 v17, 0xffff0000, v38
    v_pk_add_f32 v[108:109], v[108:109], v[16:17]
    v_lshlrev_b32 v18, 16, v39
    v_and_b32 v19, 0xffff0000, v39
    v_pk_add_f32 v[110:111], v[110:111], v[18:19]
    v_lshlrev_b32 v16, 16, v40
    v_and_b32 v17, 0xffff0000, v40
    v_pk_add_f32 v[96:97], v[96:97], v[16:17]
    v_lshlrev_b32 v18, 16, v41
    v_and_b32 v19, 0xffff0000, v41
    v_pk_add_f32 v[98:99], v[98:99], v[18:19]
    v_lshlrev_b32 v16, 16, v42
    v_and_b32 v17, 0xffff0000, v42
    v_pk_add_f32 v[100:101], v[100:101], v[16:17]
    v_lshlrev_b32 v18, 16, v43
    v_and_b32 v19, 0xffff0000, v43
    v_pk_add_f32 v[102:103], v[102:103], v[18:19]
    v_lshlrev_b32 v16, 16, v44
    v_and_b32 v17, 0xffff0000, v44
    v_pk_add_f32 v[104:105], v[104:105], v[16:17]
    v_lshlrev_b32 v18, 16, v45
    v_and_b32 v19, 0xffff0000, v45
    v_pk_add_f32 v[106:107], v[106:107], v[18:19]
    v_lshlrev_b32 v16, 16, v46
    v_and_b32 v17, 0xffff0000, v46
    v_pk_add_f32 v[108:109], v[108:109], v[16:17]
    v_lshlrev_b32 v18, 16, v47
    v_and_b32 v19, 0xffff0000, v47
    v_pk_add_f32 v[110:111], v[110:111], v[18:19]
    s_waitcnt vmcnt(2)
    v_lshlrev_b32 v16, 16, v128
    v_and_b32 v17, 0xffff0000, v128
    v_pk_add_f32 v[96:97], v[96:97], v[16:17]
    v_lshlrev_b32 v18, 16, v129
    v_and_b32 v19, 0xffff0000, v129
    v_pk_add_f32 v[98:99], v[98:99], v[18:19]
    v_lshlrev_b32 v16, 16, v130
    v_and_b32 v17, 0xffff0000, v130
    v_pk_add_f32 v[100:101], v[100:101], v[16:17]
    v_lshlrev_b32 v18, 16, v131
    v_and_b32 v19, 0xffff0000, v131
    v_pk_add_f32 v[102:103], v[102:103], v[18:19]
    v_lshlrev_b32 v16, 16, v132
    v_and_b32 v17, 0xffff0000, v132
    v_pk_add_f32 v[104:105], v[104:105], v[16:17]
    v_lshlrev_b32 v18, 16, v133
    v_and_b32 v19, 0xffff0000, v133
    v_pk_add_f32 v[106:107], v[106:107], v[18:19]
    v_lshlrev_b32 v16, 16, v134
    v_and_b32 v17, 0xffff0000, v134
    v_pk_add_f32 v[108:109], v[108:109], v[16:17]
    v_lshlrev_b32 v18, 16, v135
    v_and_b32 v19, 0xffff0000, v135
    v_pk_add_f32 v[110:111], v[110:111], v[18:19]
    v_lshlrev_b32 v16, 16, v136
    v_and_b32 v17, 0xffff0000, v136
    v_pk_add_f32 v[96:97], v[96:97], v[16:17]
    v_lshlrev_b32 v18, 16, v137
    v_and_b32 v19, 0xffff0000, v137
    v_pk_add_f32 v[98:99], v[98:99], v[18:19]
    v_lshlrev_b32 v16, 16, v138
    v_and_b32 v17, 0xffff0000, v138
    v_pk_add_f32 v[100:101], v[100:101], v[16:17]
    v_lshlrev_b32 v18, 16, v139
    v_and_b32 v19, 0xffff0000, v139
    v_pk_add_f32 v[102:103], v[102:103], v[18:19]
    v_lshlrev_b32 v16, 16, v140
    v_and_b32 v17, 0xffff0000, v140
    v_pk_add_f32 v[104:105], v[104:105], v[16:17]
    v_lshlrev_b32 v18, 16, v141
    v_and_b32 v19, 0xffff0000, v141
    v_pk_add_f32 v[106:107], v[106:107], v[18:19]
    v_lshlrev_b32 v16, 16, v142
    v_and_b32 v17, 0xffff0000, v142
    v_pk_add_f32 v[108:109], v[108:109], v[16:17]
    v_lshlrev_b32 v18, 16, v143
    v_and_b32 v19, 0xffff0000, v143
    v_pk_add_f32 v[110:111], v[110:111], v[18:19]
    s_waitcnt vmcnt(0)
    v_lshlrev_b32 v16, 16, v144
    v_and_b32 v17, 0xffff0000, v144
    v_pk_add_f32 v[96:97], v[96:97], v[16:17]
    v_lshlrev_b32 v18, 16, v145
    v_and_b32 v19, 0xffff0000, v145
    v_pk_add_f32 v[98:99], v[98:99], v[18:19]
    v_lshlrev_b32 v16, 16, v146
    v_and_b32 v17, 0xffff0000, v146
    v_pk_add_f32 v[100:101], v[100:101], v[16:17]
    v_lshlrev_b32 v18, 16, v147
    v_and_b32 v19, 0xffff0000, v147
    v_pk_add_f32 v[102:103], v[102:103], v[18:19]
    v_lshlrev_b32 v16, 16, v148
    v_and_b32 v17, 0xffff0000, v148
    v_pk_add_f32 v[104:105], v[104:105], v[16:17]
    v_lshlrev_b32 v18, 16, v149
    v_and_b32 v19, 0xffff0000, v149
    v_pk_add_f32 v[106:107], v[106:107], v[18:19]
    v_lshlrev_b32 v16, 16, v150
    v_and_b32 v17, 0xffff0000, v150
    v_pk_add_f32 v[108:109], v[108:109], v[16:17]
    v_lshlrev_b32 v18, 16, v151
    v_and_b32 v19, 0xffff0000, v151
    v_pk_add_f32 v[110:111], v[110:111], v[18:19]
    s_add_u32 s100, s18, 32768
    v_cvt_pk_bf16_f32 v96, v96, v97
    v_cvt_pk_bf16_f32 v97, v98, v99
    v_cvt_pk_bf16_f32 v98, v100, v101
    v_cvt_pk_bf16_f32 v99, v102, v103
    v_cvt_pk_bf16_f32 v104, v104, v105
    v_cvt_pk_bf16_f32 v105, v106, v107
    v_cvt_pk_bf16_f32 v106, v108, v109
    v_cvt_pk_bf16_f32 v107, v110, v111
    v_permlane16_swap_b32 v96, v98
    v_permlane16_swap_b32 v97, v99
    buffer_store_dwordx4 v[96:99], v15, s[4:7], s18 offen
    v_permlane16_swap_b32 v104, v106
    v_permlane16_swap_b32 v105, v107
    buffer_store_dwordx4 v[104:107], v15, s[4:7], s100 offen
    s_endpgm
L_rdy:
    s_mov_b32 s19, 0
L_rdy_l:
    s_load_dword s14, s[6:7], s13 glc
    s_add_u32 s19, s19, 1
    s_waitcnt lgkmcnt(0)
    s_cmp_ge_u32 s14, 1
    s_cbranch_scc1 L_rdy_ok
    s_cmp_lt_u32 s19, 0x40000
    s_cbranch_scc1 L_rdy_l
    s_branch L_rdy_ok
L_cP:
    s_mov_b32 s19, 0
L_cP_l:
    s_waitcnt lgkmcnt(0)
    s_bitcmp1_b32 s10, 17
    s_cbranch_scc1 L_cP_ok
    s_load_dword s10, s[8:9], s12 glc
    s_add_u32 s19, s19, 1
    s_cmp_lt_u32 s19, 0x80000
    s_cbranch_scc1 L_cP_l
    s_branch L_cP_ok
L_cA:
    s_mov_b32 s19, 0
L_cA_l:
    s_waitcnt lgkmcnt(0)
    s_bitcmp1_b32 s10, 1
    s_cbranch_scc1 L_cA_ok
    s_load_dword s10, s[8:9], s12 glc
    s_add_u32 s19, s19, 1
    s_cmp_lt_u32 s19, 0x80000
    s_cbranch_scc1 L_cA_l
    s_branch L_cA_ok
L_cB:
    s_mov_b32 s19, 0
L_cB_l:
    s_waitcnt lgkmcnt(0)
    s_bitcmp1_b32 s10, 5
    s_cbranch_scc1 L_cB_ok
    s_load_dword s10, s[8:9], s12 glc
    s_add_u32 s19, s19, 1
    s_cmp_lt_u32 s19, 0x80000
    s_cbranch_scc1 L_cB_l
    s_branch L_cB_ok
L_cC:
    s_mov_b32 s19, 0
L_cC_l:
    s_waitcnt lgkmcnt(0)
    s_bitcmp1_b32 s10, 9
    s_cbranch_scc1 L_cC_ok
    s_load_dword s10, s[8:9], s12 glc
    s_add_u32 s19, s19, 1
    s_cmp_lt_u32 s19, 0x80000
    s_cbranch_scc1 L_cC_l
    s_branch L_cC_ok
L_cD:
    s_mov_b32 s19, 0
L_cD_l:
    s_waitcnt lgkmcnt(0)
    s_bitcmp1_b32 s10, 12
    s_cbranch_scc1 L_cD_ok
    s_load_dword s10, s[8:9], s12 glc
    s_add_u32 s19, s19, 1
    s_cmp_lt_u32 s19, 0x80000
    s_cbranch_scc1 L_cD_l
    s_branch L_cD_ok
L_main_end:
    s_endpgm
.section .rodata,"a"
.p2align 6
.amdhsa_kernel concat_heads__mha_block_cached__mha_block_cached__near_ridge_kernel
  .amdhsa_next_free_vgpr 512
  .amdhsa_next_free_sgpr 102
  .amdhsa_accum_offset 256
  .amdhsa_group_segment_fixed_size 0
  .amdhsa_kernarg_size 104
  .amdhsa_user_sgpr_count 2
  .amdhsa_user_sgpr_kernarg_segment_ptr 1
  .amdhsa_system_sgpr_workgroup_id_x 1
.end_amdhsa_kernel
```
